```python
import torch

def _softmax(x, axis=-1):
    return torch.softmax(x, dim=axis)
def _gelu(x):
    return torch.nn.functional.gelu(x, approximate="tanh")
def _silu(x):
    return torch.nn.functional.silu(x)
def _sigmoid(x):
    return torch.sigmoid(x)
def _layernorm(x, axis=-1, eps=1e-5):
    m = x.mean(dim=axis, keepdim=True)
    v = x.var(dim=axis, keepdim=True, unbiased=False)
    return (x - m) / torch.sqrt(v + eps)
def _scatter_add(tgt, idx, src, axis=0):
    return tgt.clone().index_add_(axis, idx, src)
def _segment_sum(src, seg, n):
    out = torch.zeros((n,) + src.shape[1:], dtype=src.dtype)
    return out.index_add_(0, seg, src)
def _pad(x, pw):
    flat = tuple(v for pair in reversed(pw) for v in pair)
    return torch.nn.functional.pad(x, flat)

kernel_name = 'gated_mix__softmax_full_mha__ssm_conv_s4__prompt'

def setup_inputs():

    _w = (lambda a: (lambda t: t.to(torch.bfloat16) if t.is_floating_point() else t)(torch.as_tensor(a)))
    def _A_setup():
        B, S, D = 1, 2048, 512
        return {
            "x": _w((lambda *s: torch.randn(*s, dtype=torch.bfloat16) * 0.05)(B, S, D)),
            "wqkv": _w((lambda *s: torch.randn(*s, dtype=torch.bfloat16) * 0.8)(D, 3 * D)),
            "wo": _w((lambda *s: torch.randn(*s, dtype=torch.bfloat16) * 0.05)(D, D)),
        }
    _A_in = _A_setup()

    def _B_setup():
        B, L, D, N = 1, 2048, 512, 128
        A_re = -(lambda _x: torch.exp(torch.as_tensor(_x)))((lambda *s: torch.randn(*s, dtype=torch.bfloat16) * 6.4)(D, N))
        A_im = torch.pi * (lambda *s: torch.randn(*s, dtype=torch.bfloat16) * 0.1)(D, N)
        B_re = (lambda *s: torch.randn(*s, dtype=torch.bfloat16) * 0.2)(D, N)
        B_im = (lambda *s: torch.randn(*s, dtype=torch.bfloat16) * 0.2)(D, N)
        C_re = (lambda *s: torch.randn(*s, dtype=torch.bfloat16) * 0.2)(D, N)
        C_im = (lambda *s: torch.randn(*s, dtype=torch.bfloat16) * 0.2)(D, N)
        log_dt = (lambda *s: torch.randn(*s, dtype=torch.bfloat16) * 0.1)(D) * 0.5 - 4.0
        Dskip = (lambda *s: torch.randn(*s, dtype=torch.bfloat16) * 0.1)(D)
        return {
            "u": _w((lambda *s: torch.randn(*s, dtype=torch.bfloat16) * 0.05)(B, L, D)),
            "A_re": _w(A_re),
            "A_im": _w(A_im),
            "B_re": _w(B_re),
            "B_im": _w(B_im),
            "C_re": _w(C_re),
            "C_im": _w(C_im),
            "log_dt": _w(log_dt),
            "Dskip": _w(Dskip),
        }
    _B_in = _B_setup()

    return {
        "A_x": _A_in["x"],
        "A_wqkv": _A_in["wqkv"],
        "A_wo": _A_in["wo"],
        "B_u": _B_in["u"],
        "B_A_re": _B_in["A_re"],
        "B_A_im": _B_in["A_im"],
        "B_B_re": _B_in["B_re"],
        "B_B_im": _B_in["B_im"],
        "B_C_re": _B_in["C_re"],
        "B_C_im": _B_in["C_im"],
        "B_log_dt": _B_in["log_dt"],
        "B_Dskip": _B_in["Dskip"],
        "gate_w": _w((lambda *s: torch.randn(*s, dtype=torch.bfloat16) * 0.05)(512) * 16.0),
    }

def reference(A_x, A_wqkv, A_wo, B_u, B_A_re, B_A_im, B_B_re, B_B_im, B_C_re, B_C_im, B_log_dt, B_Dskip, gate_w):
    def _A_ref(x, wqkv, wo):
        B, S, D = x.shape
        H = 32; Dh = D // H
        qkv = (lambda x, *d: x.permute(*d))((x @ wqkv).reshape(B, S, 3, H, Dh), 2, 0, 3, 1, 4)
        q, k, v = qkv[0], qkv[1], qkv[2]
        scale = Dh ** -0.5
        scores = torch.einsum("bhqd,bhkd->bhqk", q, k) * scale
        p = _softmax(scores, axis=-1)
        o = torch.einsum("bhqk,bhkd->bhqd", p, v)
        return (lambda x, *d: x.permute(*d))(o, 0, 2, 1, 3).reshape(B, S, D) @ wo

    def _B_ref(u, A_re, A_im, B_re, B_im, C_re, C_im, log_dt, Dskip):
        Bsz, L, D = u.shape
        dt = torch.exp(log_dt)[:, None]
        A = A_re + 1j * A_im
        Bc = B_re + 1j * B_im
        Cc = C_re + 1j * C_im
        logdA = dt * A
        dB = dt * Bc
        l = (lambda x, dt: x.to(dt))(torch.arange(L), A_re.dtype)
        P = torch.exp(logdA[:, :, None] * l[None, None, :])
        K = torch.einsum("dn,dnl,dn->dl", Cc, P, dB).real
        L2 = 2 * L
        Kp = _pad(K, ((0, 0), (0, L)))
        up = (lambda x, *d: x.permute(*d))(u, 0, 2, 1)
        up = _pad(up, ((0, 0), (0, 0), (0, L)))
        Kf = (lambda x, axes=(-2,-1): torch.fft.rfft2(x.float(), dim=axes))(Kp[:, None, :], axes=(-2, -1))
        Uf = (lambda x, axes=(-2,-1): torch.fft.rfft2(x.float(), dim=axes))(up[:, :, None, :], axes=(-2, -1))
        Yf = Uf * Kf[None, :, :, :]
        y = (lambda x, s, axes=(-2,-1): torch.fft.irfft2(x, s=s, dim=axes).to(torch.bfloat16))(Yf, (1, L2), axes=(-2, -1))[:, :, 0, :L]
        y = (lambda x, *d: x.permute(*d))(y, 0, 2, 1) + u * Dskip[None, None, :]
        return y

    x = A_x
    g = _sigmoid((x * gate_w).sum(-1, keepdims=True))
    a = _A_ref(x, A_wqkv, A_wo)
    b = _B_ref(x, B_A_re, B_A_im, B_B_re, B_B_im, B_C_re, B_C_im, B_log_dt, B_Dskip)
    return g * a + (1 - g) * b
```

```asm
; @launch grid=(256,1,1) block=(512,1,1) lds=163840
.amdgcn_target "amdgcn-amd-amdhsa--gfx950"
.text
.globl gated_mix__softmax_full_mha__ssm_conv_s4__prompt_kernel
.p2align 8
.type gated_mix__softmax_full_mha__ssm_conv_s4__prompt_kernel,@function
gated_mix__softmax_full_mha__ssm_conv_s4__prompt_kernel:
    s_cmp_ge_u32 s2, 256
    s_cbranch_scc1 KF_END
    s_load_dwordx4 s[4:7], s[0:1], 0
    s_load_dwordx4 s[8:11], s[0:1], 112
    s_load_dwordx8 s[40:47], s[0:1], 32
    s_load_dwordx8 s[48:55], s[0:1], 64
    s_load_dwordx2 s[56:57], s[0:1], 96
    s_getpc_b64 s[98:99]
KF_PC:
    v_lshlrev_b32 v2, 7, v0
    v_min_u32 v2, KF_END-KF_PC, v2
    global_load_dword v224, v2, s[98:99]
    v_lshrrev_b32 v2, 6, v0
    v_and_b32 v1, 63, v0
    v_readfirstlane_b32 s24, v2
    s_and_b32 s30, s2, 7
    s_lshr_b32 s31, s2, 3
    s_lshl_b32 s3, s30, 5
    s_add_u32 s3, s3, s31
    s_lshr_b32 s25, s30, 1
    s_lshl_b32 s25, s25, 3
    s_and_b32 s32, s31, 7
    s_add_u32 s25, s25, s32
    s_and_b32 s26, s30, 1
    s_lshl_b32 s26, s26, 2
    s_lshr_b32 s32, s31, 3
    s_add_u32 s26, s26, s32
    s_mov_b32 s25, s31
    s_mov_b32 s26, s30
    s_mov_b32 s14, 0x200000
    s_mov_b32 s15, 0x00020000
    s_mov_b32 s18, 0x180000
    s_mov_b32 s19, 0x00020000
    s_mov_b32 s22, 0x1800000
    s_mov_b32 s23, 0x00020000
    s_mov_b32 s62, 0x100
    s_mov_b32 s63, 0x00020000
    s_cmp_eq_u32 s24, 4
    s_cbranch_scc1 KF_LX
    s_cmp_eq_u32 s24, 5
    s_cbranch_scc1 KF_LW
    s_cmp_ge_u32 s24, 6
    s_cbranch_scc1 KF_HP
    s_cmp_ge_u32 s24, 2
    s_cbranch_scc1 KF_CX
    s_and_b32 s29, s24, 1
    s_lshl_b32 s27, s3, 1
    s_add_u32 s27, s27, s29
    s_lshl_b32 s28, s27, 8
    v_lshlrev_b32 v2, 2, v1
    v_add_u32 v2, s28, v2
    s_lshl_b32 s28, s27, 1
    v_mov_b32 v3, s28
    s_waitcnt lgkmcnt(0)
    global_load_ushort v10, v3, s[52:53]
    global_load_dword v4, v2, s[40:41]
    global_load_dword v5, v2, s[42:43]
    s_waitcnt lgkmcnt(0)
    s_mov_b32 s12, s4
    s_and_b32 s13, s5, 0xffff
    s_mov_b32 s16, s6
    s_and_b32 s17, s7, 0xffff
    s_mov_b32 s20, s10
    s_and_b32 s21, s11, 0xffff
    s_mov_b32 s60, s8
    s_and_b32 s61, s9, 0xffff
    s_barrier
    s_mul_i32 s28, s29, 30720
    v_lshlrev_b32 v2, 3, v1
    v_add_u32 v2, s28, v2
    s_mov_b32 s32, 0x3fb8aa3b
    s_mov_b32 s33, 0x32a57060
    s_mov_b32 s34, 0x3f317218
    s_mov_b32 s35, 0x3e22f983
    s_mov_b32 s36, 0xffff0000
    s_waitcnt vmcnt(0)
    v_lshlrev_b32 v10, 16, v10
    v_mul_f32 v14, s32, v10
    v_exp_f32 v15, v14
    v_fma_f32 v16, v10, s32, -v14
    v_fma_f32 v16, v10, s33, v16
    v_mul_f32 v16, s34, v16
    v_fma_f32 v15, v15, v16, v15
    v_cvt_pk_bf16_f32 v15, v15, v15
    v_and_b32 v15, s36, v15
    v_lshlrev_b32 v50, 16, v4
    v_and_b32 v100, s36, v4
    v_lshlrev_b32 v51, 16, v5
    v_and_b32 v101, s36, v5
    v_mul_f32 v50, v15, v50
    v_mul_f32 v100, v15, v100
    v_mul_f32 v51, v15, v51
    v_mul_f32 v101, v15, v101
    v_mul_f32 v20, s32, v50
    v_mul_f32 v70, s32, v100
    v_mul_f32 v21, s35, v51
    v_mul_f32 v71, s35, v101
    v_mul_f32 v50, 0x41000000, v20
    v_mul_f32 v100, 0x41000000, v70
    v_mul_f32 v51, 0x41000000, v21
    v_mul_f32 v101, 0x41000000, v71
    v_fract_f32 v51, v51
    v_fract_f32 v101, v101
    v_exp_f32 v50, v50
    v_exp_f32 v100, v100
    v_cos_f32 v52, v51
    v_cos_f32 v102, v101
    v_sin_f32 v53, v51
    v_sin_f32 v103, v101
    v_mul_f32 v26, v50, v52
    v_mul_f32 v76, v100, v102
    v_mul_f32 v27, v50, v53
    v_mul_f32 v77, v100, v103
    v_mul_f32 v50, 0x42000000, v20
    v_mul_f32 v100, 0x42000000, v70
    v_mul_f32 v51, 0x42000000, v21
    v_mul_f32 v101, 0x42000000, v71
    v_fract_f32 v51, v51
    v_fract_f32 v101, v101
    v_exp_f32 v50, v50
    v_exp_f32 v100, v100
    v_cos_f32 v52, v51
    v_cos_f32 v102, v101
    v_sin_f32 v53, v51
    v_sin_f32 v103, v101
    v_mul_f32 v30, v50, v52
    v_mul_f32 v80, v100, v102
    v_mul_f32 v31, v50, v53
    v_mul_f32 v81, v100, v103
    v_mov_b32 v132, 0x00003f80
    v_mov_b32 v133, 0x00003f80
    ds_write_b64 v2, v[132:133] offset:13200
    v_cvt_pk_bf16_f32 v120, v26, v27
    v_cvt_pk_bf16_f32 v121, v76, v77
    ds_write_b64 v2, v[120:121] offset:13728
    v_cvt_pk_bf16_f32 v122, v30, v31
    v_cvt_pk_bf16_f32 v123, v80, v81
    ds_write_b64 v2, v[122:123] offset:15312
    v_pk_mul_f32 v[32:33], v[26:27], v[26:27] op_sel:[0,0] op_sel_hi:[0,1]
    v_pk_mul_f32 v[82:83], v[76:77], v[76:77] op_sel:[0,0] op_sel_hi:[0,1]
    v_pk_mul_f32 v[34:35], v[26:27], v[30:31] op_sel:[0,0] op_sel_hi:[0,1]
    v_pk_mul_f32 v[84:85], v[76:77], v[80:81] op_sel:[0,0] op_sel_hi:[0,1]
    v_pk_mul_f32 v[36:37], v[30:31], v[30:31] op_sel:[0,0] op_sel_hi:[0,1]
    v_pk_mul_f32 v[86:87], v[80:81], v[80:81] op_sel:[0,0] op_sel_hi:[0,1]
    v_pk_fma_f32 v[38:39], v[26:27], v[26:27], v[32:33] op_sel:[1,1,0] op_sel_hi:[1,0,1] neg_lo:[1,0,0]
    v_pk_fma_f32 v[88:89], v[76:77], v[76:77], v[82:83] op_sel:[1,1,0] op_sel_hi:[1,0,1] neg_lo:[1,0,0]
    v_pk_fma_f32 v[58:59], v[26:27], v[30:31], v[34:35] op_sel:[1,1,0] op_sel_hi:[1,0,1] neg_lo:[1,0,0]
    v_pk_fma_f32 v[108:109], v[76:77], v[80:81], v[84:85] op_sel:[1,1,0] op_sel_hi:[1,0,1] neg_lo:[1,0,0]
    v_pk_fma_f32 v[60:61], v[30:31], v[30:31], v[36:37] op_sel:[1,1,0] op_sel_hi:[1,0,1] neg_lo:[1,0,0]
    v_pk_fma_f32 v[110:111], v[80:81], v[80:81], v[86:87] op_sel:[1,1,0] op_sel_hi:[1,0,1] neg_lo:[1,0,0]
    v_cvt_pk_bf16_f32 v124, v38, v39
    v_cvt_pk_bf16_f32 v125, v88, v89
    ds_write_b64 v2, v[124:125] offset:14256
    v_cvt_pk_bf16_f32 v126, v58, v59
    v_cvt_pk_bf16_f32 v127, v108, v109
    ds_write_b64 v2, v[126:127] offset:15840
    v_cvt_pk_bf16_f32 v128, v60, v61
    v_cvt_pk_bf16_f32 v129, v110, v111
    ds_write_b64 v2, v[128:129] offset:17424
    v_pk_mul_f32 v[32:33], v[38:39], v[26:27] op_sel:[0,0] op_sel_hi:[0,1]
    v_pk_mul_f32 v[82:83], v[88:89], v[76:77] op_sel:[0,0] op_sel_hi:[0,1]
    v_pk_mul_f32 v[34:35], v[58:59], v[30:31] op_sel:[0,0] op_sel_hi:[0,1]
    v_pk_mul_f32 v[84:85], v[108:109], v[80:81] op_sel:[0,0] op_sel_hi:[0,1]
    v_pk_mul_f32 v[36:37], v[60:61], v[30:31] op_sel:[0,0] op_sel_hi:[0,1]
    v_pk_mul_f32 v[86:87], v[110:111], v[80:81] op_sel:[0,0] op_sel_hi:[0,1]
    v_pk_fma_f32 v[40:41], v[38:39], v[26:27], v[32:33] op_sel:[1,1,0] op_sel_hi:[1,0,1] neg_lo:[1,0,0]
    v_pk_fma_f32 v[90:91], v[88:89], v[76:77], v[82:83] op_sel:[1,1,0] op_sel_hi:[1,0,1] neg_lo:[1,0,0]
    v_pk_fma_f32 v[58:59], v[58:59], v[30:31], v[34:35] op_sel:[1,1,0] op_sel_hi:[1,0,1] neg_lo:[1,0,0]
    v_pk_fma_f32 v[108:109], v[108:109], v[80:81], v[84:85] op_sel:[1,1,0] op_sel_hi:[1,0,1] neg_lo:[1,0,0]
    v_pk_fma_f32 v[60:61], v[60:61], v[30:31], v[36:37] op_sel:[1,1,0] op_sel_hi:[1,0,1] neg_lo:[1,0,0]
    v_pk_fma_f32 v[110:111], v[110:111], v[80:81], v[86:87] op_sel:[1,1,0] op_sel_hi:[1,0,1] neg_lo:[1,0,0]
    v_cvt_pk_bf16_f32 v130, v40, v41
    v_cvt_pk_bf16_f32 v131, v90, v91
    ds_write_b64 v2, v[130:131] offset:14784
    v_cvt_pk_bf16_f32 v120, v58, v59
    v_cvt_pk_bf16_f32 v121, v108, v109
    ds_write_b64 v2, v[120:121] offset:17952
    v_cvt_pk_bf16_f32 v122, v60, v61
    v_cvt_pk_bf16_f32 v123, v110, v111
    ds_write_b64 v2, v[122:123] offset:19536
    v_pk_mul_f32 v[32:33], v[38:39], v[30:31] op_sel:[0,0] op_sel_hi:[0,1]
    v_pk_mul_f32 v[82:83], v[88:89], v[80:81] op_sel:[0,0] op_sel_hi:[0,1]
    v_pk_mul_f32 v[34:35], v[40:41], v[30:31] op_sel:[0,0] op_sel_hi:[0,1]
    v_pk_mul_f32 v[84:85], v[90:91], v[80:81] op_sel:[0,0] op_sel_hi:[0,1]
    v_pk_mul_f32 v[36:37], v[58:59], v[30:31] op_sel:[0,0] op_sel_hi:[0,1]
    v_pk_mul_f32 v[86:87], v[108:109], v[80:81] op_sel:[0,0] op_sel_hi:[0,1]
    v_pk_mul_f32 v[62:63], v[60:61], v[30:31] op_sel:[0,0] op_sel_hi:[0,1]
    v_pk_mul_f32 v[112:113], v[110:111], v[80:81] op_sel:[0,0] op_sel_hi:[0,1]
    v_pk_fma_f32 v[38:39], v[38:39], v[30:31], v[32:33] op_sel:[1,1,0] op_sel_hi:[1,0,1] neg_lo:[1,0,0]
    v_pk_fma_f32 v[88:89], v[88:89], v[80:81], v[82:83] op_sel:[1,1,0] op_sel_hi:[1,0,1] neg_lo:[1,0,0]
    v_pk_fma_f32 v[40:41], v[40:41], v[30:31], v[34:35] op_sel:[1,1,0] op_sel_hi:[1,0,1] neg_lo:[1,0,0]
    v_pk_fma_f32 v[90:91], v[90:91], v[80:81], v[84:85] op_sel:[1,1,0] op_sel_hi:[1,0,1] neg_lo:[1,0,0]
    v_pk_fma_f32 v[58:59], v[58:59], v[30:31], v[36:37] op_sel:[1,1,0] op_sel_hi:[1,0,1] neg_lo:[1,0,0]
    v_pk_fma_f32 v[108:109], v[108:109], v[80:81], v[86:87] op_sel:[1,1,0] op_sel_hi:[1,0,1] neg_lo:[1,0,0]
    v_pk_fma_f32 v[60:61], v[60:61], v[30:31], v[62:63] op_sel:[1,1,0] op_sel_hi:[1,0,1] neg_lo:[1,0,0]
    v_pk_fma_f32 v[110:111], v[110:111], v[80:81], v[112:113] op_sel:[1,1,0] op_sel_hi:[1,0,1] neg_lo:[1,0,0]
    v_cvt_pk_bf16_f32 v124, v38, v39
    v_cvt_pk_bf16_f32 v125, v88, v89
    ds_write_b64 v2, v[124:125] offset:16368
    v_cvt_pk_bf16_f32 v126, v40, v41
    v_cvt_pk_bf16_f32 v127, v90, v91
    ds_write_b64 v2, v[126:127] offset:16896
    v_cvt_pk_bf16_f32 v128, v58, v59
    v_cvt_pk_bf16_f32 v129, v108, v109
    ds_write_b64 v2, v[128:129] offset:20064
    v_cvt_pk_bf16_f32 v130, v60, v61
    v_cvt_pk_bf16_f32 v131, v110, v111
    ds_write_b64 v2, v[130:131] offset:21648
    v_pk_mul_f32 v[32:33], v[38:39], v[30:31] op_sel:[0,0] op_sel_hi:[0,1]
    v_pk_mul_f32 v[82:83], v[88:89], v[80:81] op_sel:[0,0] op_sel_hi:[0,1]
    v_pk_mul_f32 v[34:35], v[40:41], v[30:31] op_sel:[0,0] op_sel_hi:[0,1]
    v_pk_mul_f32 v[84:85], v[90:91], v[80:81] op_sel:[0,0] op_sel_hi:[0,1]
    v_pk_mul_f32 v[36:37], v[58:59], v[30:31] op_sel:[0,0] op_sel_hi:[0,1]
    v_pk_mul_f32 v[86:87], v[108:109], v[80:81] op_sel:[0,0] op_sel_hi:[0,1]
    v_pk_mul_f32 v[62:63], v[60:61], v[30:31] op_sel:[0,0] op_sel_hi:[0,1]
    v_pk_mul_f32 v[112:113], v[110:111], v[80:81] op_sel:[0,0] op_sel_hi:[0,1]
    v_pk_fma_f32 v[38:39], v[38:39], v[30:31], v[32:33] op_sel:[1,1,0] op_sel_hi:[1,0,1] neg_lo:[1,0,0]
    v_pk_fma_f32 v[88:89], v[88:89], v[80:81], v[82:83] op_sel:[1,1,0] op_sel_hi:[1,0,1] neg_lo:[1,0,0]
    v_pk_fma_f32 v[40:41], v[40:41], v[30:31], v[34:35] op_sel:[1,1,0] op_sel_hi:[1,0,1] neg_lo:[1,0,0]
    v_pk_fma_f32 v[90:91], v[90:91], v[80:81], v[84:85] op_sel:[1,1,0] op_sel_hi:[1,0,1] neg_lo:[1,0,0]
    v_pk_fma_f32 v[58:59], v[58:59], v[30:31], v[36:37] op_sel:[1,1,0] op_sel_hi:[1,0,1] neg_lo:[1,0,0]
    v_pk_fma_f32 v[108:109], v[108:109], v[80:81], v[86:87] op_sel:[1,1,0] op_sel_hi:[1,0,1] neg_lo:[1,0,0]
    v_pk_fma_f32 v[60:61], v[60:61], v[30:31], v[62:63] op_sel:[1,1,0] op_sel_hi:[1,0,1] neg_lo:[1,0,0]
    v_pk_fma_f32 v[110:111], v[110:111], v[80:81], v[112:113] op_sel:[1,1,0] op_sel_hi:[1,0,1] neg_lo:[1,0,0]
    v_cvt_pk_bf16_f32 v120, v38, v39
    v_cvt_pk_bf16_f32 v121, v88, v89
    ds_write_b64 v2, v[120:121] offset:18480
    v_cvt_pk_bf16_f32 v122, v40, v41
    v_cvt_pk_bf16_f32 v123, v90, v91
    ds_write_b64 v2, v[122:123] offset:19008
    v_cvt_pk_bf16_f32 v124, v58, v59
    v_cvt_pk_bf16_f32 v125, v108, v109
    ds_write_b64 v2, v[124:125] offset:22176
    v_cvt_pk_bf16_f32 v126, v60, v61
    v_cvt_pk_bf16_f32 v127, v110, v111
    ds_write_b64 v2, v[126:127] offset:23760
    v_pk_mul_f32 v[32:33], v[38:39], v[30:31] op_sel:[0,0] op_sel_hi:[0,1]
    v_pk_mul_f32 v[82:83], v[88:89], v[80:81] op_sel:[0,0] op_sel_hi:[0,1]
    v_pk_mul_f32 v[34:35], v[40:41], v[30:31] op_sel:[0,0] op_sel_hi:[0,1]
    v_pk_mul_f32 v[84:85], v[90:91], v[80:81] op_sel:[0,0] op_sel_hi:[0,1]
    v_pk_mul_f32 v[36:37], v[58:59], v[30:31] op_sel:[0,0] op_sel_hi:[0,1]
    v_pk_mul_f32 v[86:87], v[108:109], v[80:81] op_sel:[0,0] op_sel_hi:[0,1]
    v_pk_mul_f32 v[62:63], v[60:61], v[30:31] op_sel:[0,0] op_sel_hi:[0,1]
    v_pk_mul_f32 v[112:113], v[110:111], v[80:81] op_sel:[0,0] op_sel_hi:[0,1]
    v_pk_fma_f32 v[38:39], v[38:39], v[30:31], v[32:33] op_sel:[1,1,0] op_sel_hi:[1,0,1] neg_lo:[1,0,0]
    v_pk_fma_f32 v[88:89], v[88:89], v[80:81], v[82:83] op_sel:[1,1,0] op_sel_hi:[1,0,1] neg_lo:[1,0,0]
    v_pk_fma_f32 v[40:41], v[40:41], v[30:31], v[34:35] op_sel:[1,1,0] op_sel_hi:[1,0,1] neg_lo:[1,0,0]
    v_pk_fma_f32 v[90:91], v[90:91], v[80:81], v[84:85] op_sel:[1,1,0] op_sel_hi:[1,0,1] neg_lo:[1,0,0]
    v_pk_fma_f32 v[58:59], v[58:59], v[30:31], v[36:37] op_sel:[1,1,0] op_sel_hi:[1,0,1] neg_lo:[1,0,0]
    v_pk_fma_f32 v[108:109], v[108:109], v[80:81], v[86:87] op_sel:[1,1,0] op_sel_hi:[1,0,1] neg_lo:[1,0,0]
    v_pk_fma_f32 v[60:61], v[60:61], v[30:31], v[62:63] op_sel:[1,1,0] op_sel_hi:[1,0,1] neg_lo:[1,0,0]
    v_pk_fma_f32 v[110:111], v[110:111], v[80:81], v[112:113] op_sel:[1,1,0] op_sel_hi:[1,0,1] neg_lo:[1,0,0]
    v_cvt_pk_bf16_f32 v128, v38, v39
    v_cvt_pk_bf16_f32 v129, v88, v89
    ds_write_b64 v2, v[128:129] offset:20592
    v_cvt_pk_bf16_f32 v130, v40, v41
    v_cvt_pk_bf16_f32 v131, v90, v91
    ds_write_b64 v2, v[130:131] offset:21120
    v_cvt_pk_bf16_f32 v120, v58, v59
    v_cvt_pk_bf16_f32 v121, v108, v109
    ds_write_b64 v2, v[120:121] offset:24288
    v_cvt_pk_bf16_f32 v122, v60, v61
    v_cvt_pk_bf16_f32 v123, v110, v111
    ds_write_b64 v2, v[122:123] offset:25872
    v_pk_mul_f32 v[32:33], v[38:39], v[30:31] op_sel:[0,0] op_sel_hi:[0,1]
    v_pk_mul_f32 v[82:83], v[88:89], v[80:81] op_sel:[0,0] op_sel_hi:[0,1]
    v_pk_mul_f32 v[34:35], v[40:41], v[30:31] op_sel:[0,0] op_sel_hi:[0,1]
    v_pk_mul_f32 v[84:85], v[90:91], v[80:81] op_sel:[0,0] op_sel_hi:[0,1]
    v_pk_mul_f32 v[36:37], v[58:59], v[30:31] op_sel:[0,0] op_sel_hi:[0,1]
    v_pk_mul_f32 v[86:87], v[108:109], v[80:81] op_sel:[0,0] op_sel_hi:[0,1]
    v_pk_mul_f32 v[62:63], v[60:61], v[30:31] op_sel:[0,0] op_sel_hi:[0,1]
    v_pk_mul_f32 v[112:113], v[110:111], v[80:81] op_sel:[0,0] op_sel_hi:[0,1]
    v_pk_fma_f32 v[38:39], v[38:39], v[30:31], v[32:33] op_sel:[1,1,0] op_sel_hi:[1,0,1] neg_lo:[1,0,0]
    v_pk_fma_f32 v[88:89], v[88:89], v[80:81], v[82:83] op_sel:[1,1,0] op_sel_hi:[1,0,1] neg_lo:[1,0,0]
    v_pk_fma_f32 v[40:41], v[40:41], v[30:31], v[34:35] op_sel:[1,1,0] op_sel_hi:[1,0,1] neg_lo:[1,0,0]
    v_pk_fma_f32 v[90:91], v[90:91], v[80:81], v[84:85] op_sel:[1,1,0] op_sel_hi:[1,0,1] neg_lo:[1,0,0]
    v_pk_fma_f32 v[58:59], v[58:59], v[30:31], v[36:37] op_sel:[1,1,0] op_sel_hi:[1,0,1] neg_lo:[1,0,0]
    v_pk_fma_f32 v[108:109], v[108:109], v[80:81], v[86:87] op_sel:[1,1,0] op_sel_hi:[1,0,1] neg_lo:[1,0,0]
    v_pk_fma_f32 v[60:61], v[60:61], v[30:31], v[62:63] op_sel:[1,1,0] op_sel_hi:[1,0,1] neg_lo:[1,0,0]
    v_pk_fma_f32 v[110:111], v[110:111], v[80:81], v[112:113] op_sel:[1,1,0] op_sel_hi:[1,0,1] neg_lo:[1,0,0]
    v_cvt_pk_bf16_f32 v124, v38, v39
    v_cvt_pk_bf16_f32 v125, v88, v89
    ds_write_b64 v2, v[124:125] offset:22704
    v_cvt_pk_bf16_f32 v126, v40, v41
    v_cvt_pk_bf16_f32 v127, v90, v91
    ds_write_b64 v2, v[126:127] offset:23232
    v_cvt_pk_bf16_f32 v128, v58, v59
    v_cvt_pk_bf16_f32 v129, v108, v109
    ds_write_b64 v2, v[128:129] offset:26400
    v_cvt_pk_bf16_f32 v130, v60, v61
    v_cvt_pk_bf16_f32 v131, v110, v111
    ds_write_b64 v2, v[130:131] offset:27984
    v_pk_mul_f32 v[32:33], v[38:39], v[30:31] op_sel:[0,0] op_sel_hi:[0,1]
    v_pk_mul_f32 v[82:83], v[88:89], v[80:81] op_sel:[0,0] op_sel_hi:[0,1]
    v_pk_mul_f32 v[34:35], v[40:41], v[30:31] op_sel:[0,0] op_sel_hi:[0,1]
    v_pk_mul_f32 v[84:85], v[90:91], v[80:81] op_sel:[0,0] op_sel_hi:[0,1]
    v_pk_mul_f32 v[36:37], v[58:59], v[30:31] op_sel:[0,0] op_sel_hi:[0,1]
    v_pk_mul_f32 v[86:87], v[108:109], v[80:81] op_sel:[0,0] op_sel_hi:[0,1]
    v_pk_fma_f32 v[38:39], v[38:39], v[30:31], v[32:33] op_sel:[1,1,0] op_sel_hi:[1,0,1] neg_lo:[1,0,0]
    v_pk_fma_f32 v[88:89], v[88:89], v[80:81], v[82:83] op_sel:[1,1,0] op_sel_hi:[1,0,1] neg_lo:[1,0,0]
    v_pk_fma_f32 v[40:41], v[40:41], v[30:31], v[34:35] op_sel:[1,1,0] op_sel_hi:[1,0,1] neg_lo:[1,0,0]
    v_pk_fma_f32 v[90:91], v[90:91], v[80:81], v[84:85] op_sel:[1,1,0] op_sel_hi:[1,0,1] neg_lo:[1,0,0]
    v_pk_fma_f32 v[58:59], v[58:59], v[30:31], v[36:37] op_sel:[1,1,0] op_sel_hi:[1,0,1] neg_lo:[1,0,0]
    v_pk_fma_f32 v[108:109], v[108:109], v[80:81], v[86:87] op_sel:[1,1,0] op_sel_hi:[1,0,1] neg_lo:[1,0,0]
    v_cvt_pk_bf16_f32 v120, v38, v39
    v_cvt_pk_bf16_f32 v121, v88, v89
    ds_write_b64 v2, v[120:121] offset:24816
    v_cvt_pk_bf16_f32 v122, v40, v41
    v_cvt_pk_bf16_f32 v123, v90, v91
    ds_write_b64 v2, v[122:123] offset:25344
    v_cvt_pk_bf16_f32 v124, v58, v59
    v_cvt_pk_bf16_f32 v125, v108, v109
    ds_write_b64 v2, v[124:125] offset:28512
    v_pk_mul_f32 v[32:33], v[38:39], v[30:31] op_sel:[0,0] op_sel_hi:[0,1]
    v_pk_mul_f32 v[82:83], v[88:89], v[80:81] op_sel:[0,0] op_sel_hi:[0,1]
    v_pk_mul_f32 v[34:35], v[40:41], v[30:31] op_sel:[0,0] op_sel_hi:[0,1]
    v_pk_mul_f32 v[84:85], v[90:91], v[80:81] op_sel:[0,0] op_sel_hi:[0,1]
    v_pk_fma_f32 v[38:39], v[38:39], v[30:31], v[32:33] op_sel:[1,1,0] op_sel_hi:[1,0,1] neg_lo:[1,0,0]
    v_pk_fma_f32 v[88:89], v[88:89], v[80:81], v[82:83] op_sel:[1,1,0] op_sel_hi:[1,0,1] neg_lo:[1,0,0]
    v_pk_fma_f32 v[40:41], v[40:41], v[30:31], v[34:35] op_sel:[1,1,0] op_sel_hi:[1,0,1] neg_lo:[1,0,0]
    v_pk_fma_f32 v[90:91], v[90:91], v[80:81], v[84:85] op_sel:[1,1,0] op_sel_hi:[1,0,1] neg_lo:[1,0,0]
    v_cvt_pk_bf16_f32 v126, v38, v39
    v_cvt_pk_bf16_f32 v127, v88, v89
    ds_write_b64 v2, v[126:127] offset:26928
    v_cvt_pk_bf16_f32 v128, v40, v41
    v_cvt_pk_bf16_f32 v129, v90, v91
    ds_write_b64 v2, v[128:129] offset:27456
    v_pk_mul_f32 v[32:33], v[38:39], v[30:31] op_sel:[0,0] op_sel_hi:[0,1]
    v_pk_mul_f32 v[82:83], v[88:89], v[80:81] op_sel:[0,0] op_sel_hi:[0,1]
    v_pk_mul_f32 v[34:35], v[40:41], v[30:31] op_sel:[0,0] op_sel_hi:[0,1]
    v_pk_mul_f32 v[84:85], v[90:91], v[80:81] op_sel:[0,0] op_sel_hi:[0,1]
    v_pk_fma_f32 v[38:39], v[38:39], v[30:31], v[32:33] op_sel:[1,1,0] op_sel_hi:[1,0,1] neg_lo:[1,0,0]
    v_pk_fma_f32 v[88:89], v[88:89], v[80:81], v[82:83] op_sel:[1,1,0] op_sel_hi:[1,0,1] neg_lo:[1,0,0]
    v_pk_fma_f32 v[40:41], v[40:41], v[30:31], v[34:35] op_sel:[1,1,0] op_sel_hi:[1,0,1] neg_lo:[1,0,0]
    v_pk_fma_f32 v[90:91], v[90:91], v[80:81], v[84:85] op_sel:[1,1,0] op_sel_hi:[1,0,1] neg_lo:[1,0,0]
    v_cvt_pk_bf16_f32 v130, v38, v39
    v_cvt_pk_bf16_f32 v131, v88, v89
    ds_write_b64 v2, v[130:131] offset:29040
    v_cvt_pk_bf16_f32 v120, v40, v41
    v_cvt_pk_bf16_f32 v121, v90, v91
    ds_write_b64 v2, v[120:121] offset:29568
    s_branch KF_CMAIN
KF_CX:
    s_and_b32 s29, s24, 1
    s_lshl_b32 s27, s3, 1
    s_add_u32 s27, s27, s29
    s_lshl_b32 s28, s27, 8
    v_lshlrev_b32 v2, 2, v1
    v_add_u32 v2, s28, v2
    s_lshl_b32 s28, s27, 1
    v_mov_b32 v3, s28
    s_waitcnt lgkmcnt(0)
    global_load_ushort v10, v3, s[52:53]
    global_load_dword v4, v2, s[40:41]
    global_load_dword v5, v2, s[42:43]
    global_load_dword v6, v2, s[44:45]
    global_load_dword v7, v2, s[46:47]
    global_load_dword v8, v2, s[48:49]
    global_load_dword v9, v2, s[50:51]
    s_waitcnt lgkmcnt(0)
    s_mov_b32 s12, s4
    s_and_b32 s13, s5, 0xffff
    s_mov_b32 s16, s6
    s_and_b32 s17, s7, 0xffff
    s_mov_b32 s20, s10
    s_and_b32 s21, s11, 0xffff
    s_mov_b32 s60, s8
    s_and_b32 s61, s9, 0xffff
    s_lshl_b32 s59, s25, 3
    s_add_u32 s59, s59, s26
    s_lshl_b32 s59, s59, 1
    s_add_u32 s59, s59, s29
    s_lshl_b32 s58, s59, 12
    v_lshlrev_b32 v204, 4, v1
    global_load_dwordx4 v[184:187], v204, s[56:57]
    buffer_load_dwordx4 v[188:191], v204, s[12:15], s58 offen
    buffer_load_dwordx4 v[192:195], v204, s[12:15], s58 offen offset:1024
    buffer_load_dwordx4 v[196:199], v204, s[12:15], s58 offen offset:2048
    buffer_load_dwordx4 v[200:203], v204, s[12:15], s58 offen offset:3072
    s_barrier
    s_mul_i32 s28, s29, 30720
    v_lshlrev_b32 v2, 3, v1
    v_add_u32 v2, s28, v2
    s_mov_b32 s32, 0x3fb8aa3b
    s_mov_b32 s33, 0x32a57060
    s_mov_b32 s34, 0x3f317218
    s_mov_b32 s35, 0x3e22f983
    s_mov_b32 s36, 0xffff0000
    s_waitcnt vmcnt(9)
    v_lshlrev_b32 v10, 16, v10
    v_mul_f32 v14, s32, v10
    v_exp_f32 v15, v14
    v_fma_f32 v16, v10, s32, -v14
    v_fma_f32 v16, v10, s33, v16
    v_mul_f32 v16, s34, v16
    v_fma_f32 v15, v15, v16, v15
    v_cvt_pk_bf16_f32 v15, v15, v15
    v_and_b32 v15, s36, v15
    v_lshlrev_b32 v50, 16, v4
    v_and_b32 v100, s36, v4
    v_lshlrev_b32 v51, 16, v5
    v_and_b32 v101, s36, v5
    v_mul_f32 v50, v15, v50
    v_mul_f32 v100, v15, v100
    v_mul_f32 v51, v15, v51
    v_mul_f32 v101, v15, v101
    v_mul_f32 v20, s32, v50
    v_mul_f32 v70, s32, v100
    v_mul_f32 v21, s35, v51
    v_mul_f32 v71, s35, v101
    v_mul_f32 v50, 0x3f800000, v20
    v_mul_f32 v100, 0x3f800000, v70
    v_mul_f32 v51, 0x3f800000, v21
    v_mul_f32 v101, 0x3f800000, v71
    v_fract_f32 v51, v51
    v_fract_f32 v101, v101
    v_exp_f32 v50, v50
    v_exp_f32 v100, v100
    v_cos_f32 v52, v51
    v_cos_f32 v102, v101
    v_sin_f32 v53, v51
    v_sin_f32 v103, v101
    v_mul_f32 v24, v50, v52
    v_mul_f32 v74, v100, v102
    v_mul_f32 v25, v50, v53
    v_mul_f32 v75, v100, v103
    v_mul_f32 v50, 0x43800000, v20
    v_mul_f32 v100, 0x43800000, v70
    v_mul_f32 v51, 0x43800000, v21
    v_mul_f32 v101, 0x43800000, v71
    v_fract_f32 v51, v51
    v_fract_f32 v101, v101
    v_exp_f32 v50, v50
    v_exp_f32 v100, v100
    v_cos_f32 v52, v51
    v_cos_f32 v102, v101
    v_sin_f32 v53, v51
    v_sin_f32 v103, v101
    v_mul_f32 v28, v50, v52
    v_mul_f32 v78, v100, v102
    v_mul_f32 v29, v50, v53
    v_mul_f32 v79, v100, v103
    v_mul_f32 v50, 0x40000000, v20
    v_mul_f32 v100, 0x40000000, v70
    v_mul_f32 v51, 0x40000000, v21
    v_mul_f32 v101, 0x40000000, v71
    v_fract_f32 v51, v51
    v_fract_f32 v101, v101
    v_exp_f32 v50, v50
    v_exp_f32 v100, v100
    v_cos_f32 v52, v51
    v_cos_f32 v102, v101
    v_sin_f32 v53, v51
    v_sin_f32 v103, v101
    v_mul_f32 v26, v50, v52
    v_mul_f32 v76, v100, v102
    v_mul_f32 v27, v50, v53
    v_mul_f32 v77, v100, v103
    s_waitcnt vmcnt(5)
    v_lshlrev_b32 v52, 16, v6
    v_and_b32 v102, s36, v6
    v_lshlrev_b32 v53, 16, v7
    v_and_b32 v103, s36, v7
    v_lshlrev_b32 v54, 16, v8
    v_and_b32 v104, s36, v8
    v_lshlrev_b32 v55, 16, v9
    v_and_b32 v105, s36, v9
    v_mul_f32 v52, v15, v52
    v_mul_f32 v102, v15, v102
    v_mul_f32 v53, v15, v53
    v_mul_f32 v103, v15, v103
    v_mul_f32 v22, v54, v52
    v_mul_f32 v72, v104, v102
    v_mul_f32 v23, v54, v53
    v_mul_f32 v73, v104, v103
    v_fma_f32 v22, -v55, v53, v22
    v_fma_f32 v72, -v105, v103, v72
    v_fma_f32 v23, v55, v52, v23
    v_fma_f32 v73, v105, v102, v73
    v_cvt_pk_bf16_f32 v120, v22, -v23
    v_cvt_pk_bf16_f32 v121, v72, -v73
    ds_write_b64 v2, v[120:121] offset:0
    v_pk_mul_f32 v[32:33], v[22:23], v[24:25] op_sel:[0,0] op_sel_hi:[0,1]
    v_pk_mul_f32 v[82:83], v[72:73], v[74:75] op_sel:[0,0] op_sel_hi:[0,1]
    v_pk_mul_f32 v[34:35], v[22:23], v[26:27] op_sel:[0,0] op_sel_hi:[0,1]
    v_pk_mul_f32 v[84:85], v[72:73], v[76:77] op_sel:[0,0] op_sel_hi:[0,1]
    v_pk_mul_f32 v[36:37], v[22:23], v[28:29] op_sel:[0,0] op_sel_hi:[0,1]
    v_pk_mul_f32 v[86:87], v[72:73], v[78:79] op_sel:[0,0] op_sel_hi:[0,1]
    v_pk_fma_f32 v[56:57], v[22:23], v[24:25], v[32:33] op_sel:[1,1,0] op_sel_hi:[1,0,1] neg_lo:[1,0,0]
    v_pk_fma_f32 v[106:107], v[72:73], v[74:75], v[82:83] op_sel:[1,1,0] op_sel_hi:[1,0,1] neg_lo:[1,0,0]
    v_pk_fma_f32 v[42:43], v[22:23], v[26:27], v[34:35] op_sel:[1,1,0] op_sel_hi:[1,0,1] neg_lo:[1,0,0]
    v_pk_fma_f32 v[92:93], v[72:73], v[76:77], v[84:85] op_sel:[1,1,0] op_sel_hi:[1,0,1] neg_lo:[1,0,0]
    v_pk_fma_f32 v[58:59], v[22:23], v[28:29], v[36:37] op_sel:[1,1,0] op_sel_hi:[1,0,1] neg_lo:[1,0,0]
    v_pk_fma_f32 v[108:109], v[72:73], v[78:79], v[86:87] op_sel:[1,1,0] op_sel_hi:[1,0,1] neg_lo:[1,0,0]
    v_cvt_pk_bf16_f32 v122, v56, -v57
    v_cvt_pk_bf16_f32 v123, v106, -v107
    ds_write_b64 v2, v[122:123] offset:528
    v_cvt_pk_bf16_f32 v124, v42, -v43
    v_cvt_pk_bf16_f32 v125, v92, -v93
    ds_write_b64 v2, v[124:125] offset:1056
    v_cvt_pk_bf16_f32 v126, v58, -v59
    v_cvt_pk_bf16_f32 v127, v108, -v109
    ds_write_b64 v2, v[126:127] offset:4224
    v_pk_mul_f32 v[32:33], v[56:57], v[26:27] op_sel:[0,0] op_sel_hi:[0,1]
    v_pk_mul_f32 v[82:83], v[106:107], v[76:77] op_sel:[0,0] op_sel_hi:[0,1]
    v_pk_mul_f32 v[34:35], v[42:43], v[26:27] op_sel:[0,0] op_sel_hi:[0,1]
    v_pk_mul_f32 v[84:85], v[92:93], v[76:77] op_sel:[0,0] op_sel_hi:[0,1]
    v_pk_mul_f32 v[36:37], v[58:59], v[28:29] op_sel:[0,0] op_sel_hi:[0,1]
    v_pk_mul_f32 v[86:87], v[108:109], v[78:79] op_sel:[0,0] op_sel_hi:[0,1]
    v_pk_mul_f32 v[62:63], v[42:43], v[28:29] op_sel:[0,0] op_sel_hi:[0,1]
    v_pk_mul_f32 v[112:113], v[92:93], v[78:79] op_sel:[0,0] op_sel_hi:[0,1]
    v_pk_fma_f32 v[56:57], v[56:57], v[26:27], v[32:33] op_sel:[1,1,0] op_sel_hi:[1,0,1] neg_lo:[1,0,0]
    v_pk_fma_f32 v[106:107], v[106:107], v[76:77], v[82:83] op_sel:[1,1,0] op_sel_hi:[1,0,1] neg_lo:[1,0,0]
    v_pk_fma_f32 v[44:45], v[42:43], v[26:27], v[34:35] op_sel:[1,1,0] op_sel_hi:[1,0,1] neg_lo:[1,0,0]
    v_pk_fma_f32 v[94:95], v[92:93], v[76:77], v[84:85] op_sel:[1,1,0] op_sel_hi:[1,0,1] neg_lo:[1,0,0]
    v_pk_fma_f32 v[58:59], v[58:59], v[28:29], v[36:37] op_sel:[1,1,0] op_sel_hi:[1,0,1] neg_lo:[1,0,0]
    v_pk_fma_f32 v[108:109], v[108:109], v[78:79], v[86:87] op_sel:[1,1,0] op_sel_hi:[1,0,1] neg_lo:[1,0,0]
    v_pk_fma_f32 v[60:61], v[42:43], v[28:29], v[62:63] op_sel:[1,1,0] op_sel_hi:[1,0,1] neg_lo:[1,0,0]
    v_pk_fma_f32 v[110:111], v[92:93], v[78:79], v[112:113] op_sel:[1,1,0] op_sel_hi:[1,0,1] neg_lo:[1,0,0]
    v_cvt_pk_bf16_f32 v128, v56, -v57
    v_cvt_pk_bf16_f32 v129, v106, -v107
    ds_write_b64 v2, v[128:129] offset:1584
    v_cvt_pk_bf16_f32 v130, v44, -v45
    v_cvt_pk_bf16_f32 v131, v94, -v95
    ds_write_b64 v2, v[130:131] offset:2112
    v_cvt_pk_bf16_f32 v120, v58, -v59
    v_cvt_pk_bf16_f32 v121, v108, -v109
    ds_write_b64 v2, v[120:121] offset:5280
    v_cvt_pk_bf16_f32 v122, v60, -v61
    v_cvt_pk_bf16_f32 v123, v110, -v111
    ds_write_b64 v2, v[122:123] offset:4752
    v_pk_mul_f32 v[32:33], v[56:57], v[26:27] op_sel:[0,0] op_sel_hi:[0,1]
    v_pk_mul_f32 v[82:83], v[106:107], v[76:77] op_sel:[0,0] op_sel_hi:[0,1]
    v_pk_mul_f32 v[34:35], v[44:45], v[26:27] op_sel:[0,0] op_sel_hi:[0,1]
    v_pk_mul_f32 v[84:85], v[94:95], v[76:77] op_sel:[0,0] op_sel_hi:[0,1]
    v_pk_mul_f32 v[36:37], v[58:59], v[28:29] op_sel:[0,0] op_sel_hi:[0,1]
    v_pk_mul_f32 v[86:87], v[108:109], v[78:79] op_sel:[0,0] op_sel_hi:[0,1]
    v_pk_mul_f32 v[62:63], v[44:45], v[28:29] op_sel:[0,0] op_sel_hi:[0,1]
    v_pk_mul_f32 v[112:113], v[94:95], v[78:79] op_sel:[0,0] op_sel_hi:[0,1]
    v_pk_fma_f32 v[56:57], v[56:57], v[26:27], v[32:33] op_sel:[1,1,0] op_sel_hi:[1,0,1] neg_lo:[1,0,0]
    v_pk_fma_f32 v[106:107], v[106:107], v[76:77], v[82:83] op_sel:[1,1,0] op_sel_hi:[1,0,1] neg_lo:[1,0,0]
    v_pk_fma_f32 v[46:47], v[44:45], v[26:27], v[34:35] op_sel:[1,1,0] op_sel_hi:[1,0,1] neg_lo:[1,0,0]
    v_pk_fma_f32 v[96:97], v[94:95], v[76:77], v[84:85] op_sel:[1,1,0] op_sel_hi:[1,0,1] neg_lo:[1,0,0]
    v_pk_fma_f32 v[58:59], v[58:59], v[28:29], v[36:37] op_sel:[1,1,0] op_sel_hi:[1,0,1] neg_lo:[1,0,0]
    v_pk_fma_f32 v[108:109], v[108:109], v[78:79], v[86:87] op_sel:[1,1,0] op_sel_hi:[1,0,1] neg_lo:[1,0,0]
    v_pk_fma_f32 v[60:61], v[44:45], v[28:29], v[62:63] op_sel:[1,1,0] op_sel_hi:[1,0,1] neg_lo:[1,0,0]
    v_pk_fma_f32 v[110:111], v[94:95], v[78:79], v[112:113] op_sel:[1,1,0] op_sel_hi:[1,0,1] neg_lo:[1,0,0]
    v_cvt_pk_bf16_f32 v124, v56, -v57
    v_cvt_pk_bf16_f32 v125, v106, -v107
    ds_write_b64 v2, v[124:125] offset:2640
    v_cvt_pk_bf16_f32 v126, v46, -v47
    v_cvt_pk_bf16_f32 v127, v96, -v97
    ds_write_b64 v2, v[126:127] offset:3168
    v_cvt_pk_bf16_f32 v128, v58, -v59
    v_cvt_pk_bf16_f32 v129, v108, -v109
    ds_write_b64 v2, v[128:129] offset:5808
    v_cvt_pk_bf16_f32 v130, v60, -v61
    v_cvt_pk_bf16_f32 v131, v110, -v111
    ds_write_b64 v2, v[130:131] offset:6336
    v_pk_mul_f32 v[32:33], v[56:57], v[26:27] op_sel:[0,0] op_sel_hi:[0,1]
    v_pk_mul_f32 v[82:83], v[106:107], v[76:77] op_sel:[0,0] op_sel_hi:[0,1]
    v_pk_mul_f32 v[34:35], v[46:47], v[28:29] op_sel:[0,0] op_sel_hi:[0,1]
    v_pk_mul_f32 v[84:85], v[96:97], v[78:79] op_sel:[0,0] op_sel_hi:[0,1]
    v_pk_mul_f32 v[36:37], v[58:59], v[28:29] op_sel:[0,0] op_sel_hi:[0,1]
    v_pk_mul_f32 v[86:87], v[108:109], v[78:79] op_sel:[0,0] op_sel_hi:[0,1]
    v_pk_mul_f32 v[62:63], v[60:61], v[28:29] op_sel:[0,0] op_sel_hi:[0,1]
    v_pk_mul_f32 v[112:113], v[110:111], v[78:79] op_sel:[0,0] op_sel_hi:[0,1]
    v_pk_fma_f32 v[56:57], v[56:57], v[26:27], v[32:33] op_sel:[1,1,0] op_sel_hi:[1,0,1] neg_lo:[1,0,0]
    v_pk_fma_f32 v[106:107], v[106:107], v[76:77], v[82:83] op_sel:[1,1,0] op_sel_hi:[1,0,1] neg_lo:[1,0,0]
    v_pk_fma_f32 v[46:47], v[46:47], v[28:29], v[34:35] op_sel:[1,1,0] op_sel_hi:[1,0,1] neg_lo:[1,0,0]
    v_pk_fma_f32 v[96:97], v[96:97], v[78:79], v[84:85] op_sel:[1,1,0] op_sel_hi:[1,0,1] neg_lo:[1,0,0]
    v_pk_fma_f32 v[58:59], v[58:59], v[28:29], v[36:37] op_sel:[1,1,0] op_sel_hi:[1,0,1] neg_lo:[1,0,0]
    v_pk_fma_f32 v[108:109], v[108:109], v[78:79], v[86:87] op_sel:[1,1,0] op_sel_hi:[1,0,1] neg_lo:[1,0,0]
    v_pk_fma_f32 v[60:61], v[60:61], v[28:29], v[62:63] op_sel:[1,1,0] op_sel_hi:[1,0,1] neg_lo:[1,0,0]
    v_pk_fma_f32 v[110:111], v[110:111], v[78:79], v[112:113] op_sel:[1,1,0] op_sel_hi:[1,0,1] neg_lo:[1,0,0]
    v_cvt_pk_bf16_f32 v120, v56, -v57
    v_cvt_pk_bf16_f32 v121, v106, -v107
    ds_write_b64 v2, v[120:121] offset:3696
    v_cvt_pk_bf16_f32 v122, v46, -v47
    v_cvt_pk_bf16_f32 v123, v96, -v97
    ds_write_b64 v2, v[122:123] offset:6864
    v_cvt_pk_bf16_f32 v124, v58, -v59
    v_cvt_pk_bf16_f32 v125, v108, -v109
    ds_write_b64 v2, v[124:125] offset:8448
    v_cvt_pk_bf16_f32 v126, v60, -v61
    v_cvt_pk_bf16_f32 v127, v110, -v111
    ds_write_b64 v2, v[126:127] offset:7392
    v_pk_mul_f32 v[32:33], v[58:59], v[28:29] op_sel:[0,0] op_sel_hi:[0,1]
    v_pk_mul_f32 v[82:83], v[108:109], v[78:79] op_sel:[0,0] op_sel_hi:[0,1]
    v_pk_mul_f32 v[34:35], v[60:61], v[28:29] op_sel:[0,0] op_sel_hi:[0,1]
    v_pk_mul_f32 v[84:85], v[110:111], v[78:79] op_sel:[0,0] op_sel_hi:[0,1]
    v_pk_fma_f32 v[58:59], v[58:59], v[28:29], v[32:33] op_sel:[1,1,0] op_sel_hi:[1,0,1] neg_lo:[1,0,0]
    v_pk_fma_f32 v[108:109], v[108:109], v[78:79], v[82:83] op_sel:[1,1,0] op_sel_hi:[1,0,1] neg_lo:[1,0,0]
    v_pk_fma_f32 v[60:61], v[60:61], v[28:29], v[34:35] op_sel:[1,1,0] op_sel_hi:[1,0,1] neg_lo:[1,0,0]
    v_pk_fma_f32 v[110:111], v[110:111], v[78:79], v[84:85] op_sel:[1,1,0] op_sel_hi:[1,0,1] neg_lo:[1,0,0]
    v_cvt_pk_bf16_f32 v128, v58, -v59
    v_cvt_pk_bf16_f32 v129, v108, -v109
    ds_write_b64 v2, v[128:129] offset:8976
    v_cvt_pk_bf16_f32 v130, v60, -v61
    v_cvt_pk_bf16_f32 v131, v110, -v111
    ds_write_b64 v2, v[130:131] offset:7920
    v_pk_mul_f32 v[32:33], v[58:59], v[28:29] op_sel:[0,0] op_sel_hi:[0,1]
    v_pk_mul_f32 v[82:83], v[108:109], v[78:79] op_sel:[0,0] op_sel_hi:[0,1]
    v_pk_fma_f32 v[58:59], v[58:59], v[28:29], v[32:33] op_sel:[1,1,0] op_sel_hi:[1,0,1] neg_lo:[1,0,0]
    v_pk_fma_f32 v[108:109], v[108:109], v[78:79], v[82:83] op_sel:[1,1,0] op_sel_hi:[1,0,1] neg_lo:[1,0,0]
    v_cvt_pk_bf16_f32 v120, v58, -v59
    v_cvt_pk_bf16_f32 v121, v108, -v109
    ds_write_b64 v2, v[120:121] offset:9504
    v_pk_mul_f32 v[32:33], v[58:59], v[28:29] op_sel:[0,0] op_sel_hi:[0,1]
    v_pk_mul_f32 v[82:83], v[108:109], v[78:79] op_sel:[0,0] op_sel_hi:[0,1]
    v_pk_fma_f32 v[58:59], v[58:59], v[28:29], v[32:33] op_sel:[1,1,0] op_sel_hi:[1,0,1] neg_lo:[1,0,0]
    v_pk_fma_f32 v[108:109], v[108:109], v[78:79], v[82:83] op_sel:[1,1,0] op_sel_hi:[1,0,1] neg_lo:[1,0,0]
    v_cvt_pk_bf16_f32 v122, v58, -v59
    v_cvt_pk_bf16_f32 v123, v108, -v109
    ds_write_b64 v2, v[122:123] offset:10032
    v_pk_mul_f32 v[32:33], v[58:59], v[28:29] op_sel:[0,0] op_sel_hi:[0,1]
    v_pk_mul_f32 v[82:83], v[108:109], v[78:79] op_sel:[0,0] op_sel_hi:[0,1]
    v_pk_fma_f32 v[58:59], v[58:59], v[28:29], v[32:33] op_sel:[1,1,0] op_sel_hi:[1,0,1] neg_lo:[1,0,0]
    v_pk_fma_f32 v[108:109], v[108:109], v[78:79], v[82:83] op_sel:[1,1,0] op_sel_hi:[1,0,1] neg_lo:[1,0,0]
    v_cvt_pk_bf16_f32 v124, v58, -v59
    v_cvt_pk_bf16_f32 v125, v108, -v109
    ds_write_b64 v2, v[124:125] offset:12672
    s_mov_b32 s55, 0xbfb8aa3b
    s_waitcnt vmcnt(0)
    v_dot2_f32_bf16 v208, v188, v184, 0
    v_dot2_f32_bf16 v209, v192, v184, 0
    v_dot2_f32_bf16 v210, v196, v184, 0
    v_dot2_f32_bf16 v211, v200, v184, 0
    v_dot2_f32_bf16 v208, v189, v185, v208
    v_dot2_f32_bf16 v209, v193, v185, v209
    v_dot2_f32_bf16 v210, v197, v185, v210
    v_dot2_f32_bf16 v211, v201, v185, v211
    v_dot2_f32_bf16 v208, v190, v186, v208
    v_dot2_f32_bf16 v209, v194, v186, v209
    v_dot2_f32_bf16 v210, v198, v186, v210
    v_dot2_f32_bf16 v211, v202, v186, v211
    v_dot2_f32_bf16 v208, v191, v187, v208
    v_dot2_f32_bf16 v209, v195, v187, v209
    v_dot2_f32_bf16 v210, v199, v187, v210
    v_dot2_f32_bf16 v211, v203, v187, v211
    v_add_f32_dpp v208, v208, v208 row_shr:1 row_mask:0xf bank_mask:0xf bound_ctrl:0
    v_add_f32_dpp v209, v209, v209 row_shr:1 row_mask:0xf bank_mask:0xf bound_ctrl:0
    v_add_f32_dpp v210, v210, v210 row_shr:1 row_mask:0xf bank_mask:0xf bound_ctrl:0
    v_add_f32_dpp v211, v211, v211 row_shr:1 row_mask:0xf bank_mask:0xf bound_ctrl:0
    v_add_f32_dpp v208, v208, v208 row_shr:2 row_mask:0xf bank_mask:0xf bound_ctrl:0
    v_add_f32_dpp v209, v209, v209 row_shr:2 row_mask:0xf bank_mask:0xf bound_ctrl:0
    v_add_f32_dpp v210, v210, v210 row_shr:2 row_mask:0xf bank_mask:0xf bound_ctrl:0
    v_add_f32_dpp v211, v211, v211 row_shr:2 row_mask:0xf bank_mask:0xf bound_ctrl:0
    v_add_f32_dpp v208, v208, v208 row_shr:4 row_mask:0xf bank_mask:0xf bound_ctrl:0
    v_add_f32_dpp v209, v209, v209 row_shr:4 row_mask:0xf bank_mask:0xf bound_ctrl:0
    v_add_f32_dpp v210, v210, v210 row_shr:4 row_mask:0xf bank_mask:0xf bound_ctrl:0
    v_add_f32_dpp v211, v211, v211 row_shr:4 row_mask:0xf bank_mask:0xf bound_ctrl:0
    v_add_f32_dpp v208, v208, v208 row_shr:8 row_mask:0xf bank_mask:0xf bound_ctrl:0
    v_add_f32_dpp v209, v209, v209 row_shr:8 row_mask:0xf bank_mask:0xf bound_ctrl:0
    v_add_f32_dpp v210, v210, v210 row_shr:8 row_mask:0xf bank_mask:0xf bound_ctrl:0
    v_add_f32_dpp v211, v211, v211 row_shr:8 row_mask:0xf bank_mask:0xf bound_ctrl:0
    v_add_f32_dpp v208, v208, v208 row_bcast:15 row_mask:0xa bank_mask:0xf
    v_add_f32_dpp v209, v209, v209 row_bcast:15 row_mask:0xa bank_mask:0xf
    v_add_f32_dpp v210, v210, v210 row_bcast:15 row_mask:0xa bank_mask:0xf
    v_add_f32_dpp v211, v211, v211 row_bcast:15 row_mask:0xa bank_mask:0xf
    v_add_f32_dpp v208, v208, v208 row_bcast:31 row_mask:0xc bank_mask:0xf
    v_add_f32_dpp v209, v209, v209 row_bcast:31 row_mask:0xc bank_mask:0xf
    v_add_f32_dpp v210, v210, v210 row_bcast:31 row_mask:0xc bank_mask:0xf
    v_add_f32_dpp v211, v211, v211 row_bcast:31 row_mask:0xc bank_mask:0xf
    v_cvt_pk_bf16_f32 v208, v208, v208
    v_cvt_pk_bf16_f32 v209, v209, v209
    v_cvt_pk_bf16_f32 v210, v210, v210
    v_cvt_pk_bf16_f32 v211, v211, v211
    v_and_b32 v208, s36, v208
    v_and_b32 v209, s36, v209
    v_and_b32 v210, s36, v210
    v_and_b32 v211, s36, v211
    v_mul_f32 v208, s55, v208
    v_mul_f32 v209, s55, v209
    v_mul_f32 v210, s55, v210
    v_mul_f32 v211, s55, v211
    v_exp_f32 v208, v208
    v_exp_f32 v209, v209
    v_exp_f32 v210, v210
    v_exp_f32 v211, v211
    v_add_f32 v208, 1.0, v208
    v_add_f32 v209, 1.0, v209
    v_add_f32 v210, 1.0, v210
    v_add_f32 v211, 1.0, v211
    v_rcp_f32 v208, v208
    v_rcp_f32 v209, v209
    v_rcp_f32 v210, v210
    v_rcp_f32 v211, v211
    v_cvt_pk_bf16_f32 v208, v208, v208
    v_cvt_pk_bf16_f32 v209, v209, v209
    v_cvt_pk_bf16_f32 v210, v210, v210
    v_cvt_pk_bf16_f32 v211, v211, v211
    v_and_b32 v208, s36, v208
    v_and_b32 v209, s36, v209
    v_and_b32 v210, s36, v210
    v_and_b32 v211, s36, v211
KF_CMAIN:
    s_waitcnt lgkmcnt(0)
    s_and_b32 s39, s24, 1
    s_lshr_b32 s64, s24, 1
    s_lshl_b32 s29, s39, 12
    s_add_u32 s29, s29, 124928
    v_and_b32 v133, 31, v1
    v_lshrrev_b32 v134, 5, v1
    v_lshrrev_b32 v135, 1, v133
    v_xor_b32 v135, v135, v134
    v_and_b32 v135, 7, v135
    v_lshlrev_b32 v128, 7, v133
    v_lshl_add_u32 v128, v135, 4, v128
    v_add_u32 v128, s29, v128
    v_xor_b32 v129, 32, v128
    v_xor_b32 v130, 64, v128
    v_xor_b32 v131, 0x60, v128
    v_mul_u32_u24 v132, 3072, v134
    v_bfe_u32 v133, v1, 2, 2
    v_mul_u32_u24 v135, 384, v133
    v_add_u32 v132, v132, v135
    v_lshrrev_b32 v133, 1, v133
    v_xor_b32 v133, s64, v133
    v_lshl_add_u32 v132, v133, 6, v132
    v_bfe_u32 v133, v1, 4, 1
    v_lshl_add_u32 v132, v133, 5, v132
    v_and_b32 v133, 3, v1
    v_lshl_add_u32 v132, v133, 3, v132
    v_add_u32 v132, 63488, v132
    s_lshl_b32 s33, s25, 1
    s_add_u32 s33, s33, s39
    s_lshl_b32 s34, s26, 1
    s_add_u32 s34, s34, s64
    s_lshl_b32 s68, s34, 8
    s_lshl_b32 s69, s33, 2
    s_add_u32 s68, s68, s69
    s_add_u32 s68, s68, 18087936
    s_lshl_b32 s33, s33, 10
    s_lshl_b32 s34, s34, 17
    s_add_u32 s33, s33, s34
    s_add_u32 s34, s33, 0x10000
    s_add_u32 s50, s33, 2097152
    s_add_u32 s51, s33, 2162688
    s_add_u32 s52, s33, 4194304
    s_mov_b32 s58, 0x3eb8aa3b
    v_lshlrev_b32 v133, 4, v1
    v_bfe_u32 v134, v1, 4, 1
    v_lshlrev_b32 v134, 16, v134
    v_lshrrev_b32 v135, 5, v1
    v_lshl_add_u32 v134, v135, 8, v134
    v_and_b32 v135, 15, v1
    v_lshl_add_u32 v134, v135, 4, v134
    s_waitcnt lgkmcnt(0)
    s_barrier
    ds_read_b128 v[16:19], v128 offset:0
    ds_read_b64_tr_b16 v[24:25], v132 offset:0
    ds_read_b64_tr_b16 v[26:27], v132 offset:1536
    ds_read_b64_tr_b16 v[28:29], v132 offset:128
    ds_read_b64_tr_b16 v[30:31], v132 offset:1664
    ds_read_b64_tr_b16 v[32:33], v132 offset:256
    ds_read_b64_tr_b16 v[34:35], v132 offset:1792
    ds_read_b128 v[20:23], v129 offset:0
    ds_read_b64_tr_b16 v[36:37], v132 offset:6144
    ds_read_b64_tr_b16 v[38:39], v132 offset:7680
    ds_read_b64_tr_b16 v[40:41], v132 offset:6272
    ds_read_b64_tr_b16 v[42:43], v132 offset:7808
    ds_read_b64_tr_b16 v[44:45], v132 offset:6400
    ds_read_b64_tr_b16 v[46:47], v132 offset:7936
    s_waitcnt lgkmcnt(0)
    s_barrier
    v_mfma_f32_32x32x16_bf16 v[136:151], v[24:27], v[16:19], 0
    ds_read_b128 v[48:51], v130 offset:0
    ds_read_b64_tr_b16 v[56:57], v132 offset:12288
    ds_read_b64_tr_b16 v[58:59], v132 offset:13824
    v_mfma_f32_32x32x16_bf16 v[152:167], v[28:31], v[16:19], 0
    ds_read_b64_tr_b16 v[60:61], v132 offset:12416
    ds_read_b64_tr_b16 v[62:63], v132 offset:13952
    ds_read_b64_tr_b16 v[64:65], v132 offset:12544
    v_mfma_f32_32x32x16_bf16 v[168:183], v[16:19], v[32:35], 0
    ds_read_b64_tr_b16 v[66:67], v132 offset:14080
    ds_read_b128 v[52:55], v131 offset:0
    ds_read_b64_tr_b16 v[68:69], v132 offset:18432
    v_mfma_f32_32x32x16_bf16 v[136:151], v[36:39], v[20:23], v[136:151]
    ds_read_b64_tr_b16 v[70:71], v132 offset:19968
    ds_read_b64_tr_b16 v[72:73], v132 offset:18560
    ds_read_b64_tr_b16 v[74:75], v132 offset:20096
    v_mfma_f32_32x32x16_bf16 v[152:167], v[40:43], v[20:23], v[152:167]
    ds_read_b64_tr_b16 v[76:77], v132 offset:18688
    ds_read_b64_tr_b16 v[78:79], v132 offset:20224
    v_mfma_f32_32x32x16_bf16 v[168:183], v[20:23], v[44:47], v[168:183]
    s_waitcnt lgkmcnt(0)
    s_barrier
    v_mfma_f32_32x32x16_bf16 v[136:151], v[56:59], v[48:51], v[136:151]
    ds_read_b128 v[16:19], v128 offset:8192
    ds_read_b64_tr_b16 v[24:25], v132 offset:24576
    ds_read_b64_tr_b16 v[26:27], v132 offset:26112
    v_mfma_f32_32x32x16_bf16 v[152:167], v[60:63], v[48:51], v[152:167]
    ds_read_b64_tr_b16 v[28:29], v132 offset:24704
    ds_read_b64_tr_b16 v[30:31], v132 offset:26240
    ds_read_b64_tr_b16 v[32:33], v132 offset:24832
    v_mfma_f32_32x32x16_bf16 v[168:183], v[48:51], v[64:67], v[168:183]
    ds_read_b64_tr_b16 v[34:35], v132 offset:26368
    ds_read_b128 v[20:23], v129 offset:8192
    ds_read_b64_tr_b16 v[36:37], v132 offset:30720
    v_mfma_f32_32x32x16_bf16 v[136:151], v[68:71], v[52:55], v[136:151]
    ds_read_b64_tr_b16 v[38:39], v132 offset:32256
    ds_read_b64_tr_b16 v[40:41], v132 offset:30848
    ds_read_b64_tr_b16 v[42:43], v132 offset:32384
    v_mfma_f32_32x32x16_bf16 v[152:167], v[72:75], v[52:55], v[152:167]
    ds_read_b64_tr_b16 v[44:45], v132 offset:30976
    ds_read_b64_tr_b16 v[46:47], v132 offset:32512
    v_mfma_f32_32x32x16_bf16 v[168:183], v[52:55], v[76:79], v[168:183]
    s_waitcnt lgkmcnt(0)
    s_barrier
    v_mfma_f32_32x32x16_bf16 v[136:151], v[24:27], v[16:19], v[136:151]
    ds_read_b128 v[48:51], v130 offset:8192
    ds_read_b64_tr_b16 v[56:57], v132 offset:36864
    ds_read_b64_tr_b16 v[58:59], v132 offset:38400
    v_mfma_f32_32x32x16_bf16 v[152:167], v[28:31], v[16:19], v[152:167]
    ds_read_b64_tr_b16 v[60:61], v132 offset:36992
    ds_read_b64_tr_b16 v[62:63], v132 offset:38528
    ds_read_b64_tr_b16 v[64:65], v132 offset:37120
    v_mfma_f32_32x32x16_bf16 v[168:183], v[16:19], v[32:35], v[168:183]
    ds_read_b64_tr_b16 v[66:67], v132 offset:38656
    ds_read_b128 v[52:55], v131 offset:8192
    ds_read_b64_tr_b16 v[68:69], v132 offset:43008
    v_mfma_f32_32x32x16_bf16 v[136:151], v[36:39], v[20:23], v[136:151]
    ds_read_b64_tr_b16 v[70:71], v132 offset:44544
    ds_read_b64_tr_b16 v[72:73], v132 offset:43136
    ds_read_b64_tr_b16 v[74:75], v132 offset:44672
    v_mfma_f32_32x32x16_bf16 v[152:167], v[40:43], v[20:23], v[152:167]
    ds_read_b64_tr_b16 v[76:77], v132 offset:43264
    ds_read_b64_tr_b16 v[78:79], v132 offset:44800
    v_mfma_f32_32x32x16_bf16 v[168:183], v[20:23], v[44:47], v[168:183]
    s_waitcnt lgkmcnt(0)
    s_barrier
    v_mfma_f32_32x32x16_bf16 v[136:151], v[56:59], v[48:51], v[136:151]
    ds_read_b128 v[16:19], v128 offset:16384
    ds_read_b64_tr_b16 v[24:25], v132 offset:49152
    ds_read_b64_tr_b16 v[26:27], v132 offset:50688
    v_mfma_f32_32x32x16_bf16 v[152:167], v[60:63], v[48:51], v[152:167]
    ds_read_b64_tr_b16 v[28:29], v132 offset:49280
    ds_read_b64_tr_b16 v[30:31], v132 offset:50816
    ds_read_b64_tr_b16 v[32:33], v132 offset:49408
    v_mfma_f32_32x32x16_bf16 v[168:183], v[48:51], v[64:67], v[168:183]
    ds_read_b64_tr_b16 v[34:35], v132 offset:50944
    ds_read_b128 v[20:23], v129 offset:16384
    ds_read_b64_tr_b16 v[36:37], v132 offset:55296
    v_mfma_f32_32x32x16_bf16 v[136:151], v[68:71], v[52:55], v[136:151]
    ds_read_b64_tr_b16 v[38:39], v132 offset:56832
    ds_read_b64_tr_b16 v[40:41], v132 offset:55424
    ds_read_b64_tr_b16 v[42:43], v132 offset:56960
    v_mfma_f32_32x32x16_bf16 v[152:167], v[72:75], v[52:55], v[152:167]
    ds_read_b64_tr_b16 v[44:45], v132 offset:55552
    ds_read_b64_tr_b16 v[46:47], v132 offset:57088
    v_mfma_f32_32x32x16_bf16 v[168:183], v[52:55], v[76:79], v[168:183]
    s_waitcnt lgkmcnt(0)
    s_barrier
    v_mfma_f32_32x32x16_bf16 v[136:151], v[24:27], v[16:19], v[136:151]
    ds_read_b128 v[48:51], v130 offset:16384
    ds_read_b64_tr_b16 v[56:57], v132 offset:0
    ds_read_b64_tr_b16 v[58:59], v132 offset:1536
    v_mfma_f32_32x32x16_bf16 v[152:167], v[28:31], v[16:19], v[152:167]
    ds_read_b64_tr_b16 v[60:61], v132 offset:128
    ds_read_b64_tr_b16 v[62:63], v132 offset:1664
    ds_read_b64_tr_b16 v[64:65], v132 offset:256
    v_mfma_f32_32x32x16_bf16 v[168:183], v[16:19], v[32:35], v[168:183]
    ds_read_b64_tr_b16 v[66:67], v132 offset:1792
    ds_read_b128 v[52:55], v131 offset:16384
    ds_read_b64_tr_b16 v[68:69], v132 offset:6144
    v_mfma_f32_32x32x16_bf16 v[136:151], v[36:39], v[20:23], v[136:151]
    ds_read_b64_tr_b16 v[70:71], v132 offset:7680
    ds_read_b64_tr_b16 v[72:73], v132 offset:6272
    ds_read_b64_tr_b16 v[74:75], v132 offset:7808
    v_mfma_f32_32x32x16_bf16 v[152:167], v[40:43], v[20:23], v[152:167]
    ds_read_b64_tr_b16 v[76:77], v132 offset:6400
    ds_read_b64_tr_b16 v[78:79], v132 offset:7936
    v_mfma_f32_32x32x16_bf16 v[168:183], v[20:23], v[44:47], v[168:183]
    s_waitcnt lgkmcnt(0)
    s_barrier
    v_mfma_f32_32x32x16_bf16 v[136:151], v[56:59], v[48:51], v[136:151]
    ds_read_b128 v[16:19], v128 offset:0
    ds_read_b64_tr_b16 v[24:25], v132 offset:12288
    ds_read_b64_tr_b16 v[26:27], v132 offset:13824
    v_mfma_f32_32x32x16_bf16 v[152:167], v[60:63], v[48:51], v[152:167]
    ds_read_b64_tr_b16 v[28:29], v132 offset:12416
    ds_read_b64_tr_b16 v[30:31], v132 offset:13952
    ds_read_b64_tr_b16 v[32:33], v132 offset:12544
    v_mfma_f32_32x32x16_bf16 v[168:183], v[48:51], v[64:67], v[168:183]
    ds_read_b64_tr_b16 v[34:35], v132 offset:14080
    ds_read_b128 v[20:23], v129 offset:0
    ds_read_b64_tr_b16 v[36:37], v132 offset:18432
    v_mfma_f32_32x32x16_bf16 v[136:151], v[68:71], v[52:55], v[136:151]
    ds_read_b64_tr_b16 v[38:39], v132 offset:19968
    ds_read_b64_tr_b16 v[40:41], v132 offset:18560
    ds_read_b64_tr_b16 v[42:43], v132 offset:20096
    v_mfma_f32_32x32x16_bf16 v[152:167], v[72:75], v[52:55], v[152:167]
    ds_read_b64_tr_b16 v[44:45], v132 offset:18688
    ds_read_b64_tr_b16 v[46:47], v132 offset:20224
    v_mfma_f32_32x32x16_bf16 v[168:183], v[52:55], v[76:79], v[168:183]
    s_waitcnt lgkmcnt(0)
    s_barrier
    v_mfma_f32_32x32x16_bf16 v[136:151], v[24:27], v[16:19], v[136:151]
    ds_read_b128 v[48:51], v130 offset:0
    ds_read_b64_tr_b16 v[56:57], v132 offset:24576
    ds_read_b64_tr_b16 v[58:59], v132 offset:26112
    v_mfma_f32_32x32x16_bf16 v[152:167], v[28:31], v[16:19], v[152:167]
    ds_read_b64_tr_b16 v[60:61], v132 offset:24704
    ds_read_b64_tr_b16 v[62:63], v132 offset:26240
    ds_read_b64_tr_b16 v[64:65], v132 offset:24832
    v_mfma_f32_32x32x16_bf16 v[168:183], v[16:19], v[32:35], v[168:183]
    ds_read_b64_tr_b16 v[66:67], v132 offset:26368
    ds_read_b128 v[52:55], v131 offset:0
    ds_read_b64_tr_b16 v[68:69], v132 offset:30720
    v_mfma_f32_32x32x16_bf16 v[136:151], v[36:39], v[20:23], v[136:151]
    ds_read_b64_tr_b16 v[70:71], v132 offset:32256
    ds_read_b64_tr_b16 v[72:73], v132 offset:30848
    ds_read_b64_tr_b16 v[74:75], v132 offset:32384
    v_mfma_f32_32x32x16_bf16 v[152:167], v[40:43], v[20:23], v[152:167]
    ds_read_b64_tr_b16 v[76:77], v132 offset:30976
    ds_read_b64_tr_b16 v[78:79], v132 offset:32512
    v_mfma_f32_32x32x16_bf16 v[168:183], v[20:23], v[44:47], v[168:183]
    s_waitcnt lgkmcnt(0)
    s_barrier
    v_mfma_f32_32x32x16_bf16 v[136:151], v[56:59], v[48:51], v[136:151]
    ds_read_b128 v[16:19], v128 offset:8192
    ds_read_b64_tr_b16 v[24:25], v132 offset:36864
    ds_read_b64_tr_b16 v[26:27], v132 offset:38400
    v_mfma_f32_32x32x16_bf16 v[152:167], v[60:63], v[48:51], v[152:167]
    ds_read_b64_tr_b16 v[28:29], v132 offset:36992
    ds_read_b64_tr_b16 v[30:31], v132 offset:38528
    ds_read_b64_tr_b16 v[32:33], v132 offset:37120
    v_mfma_f32_32x32x16_bf16 v[168:183], v[48:51], v[64:67], v[168:183]
    ds_read_b64_tr_b16 v[34:35], v132 offset:38656
    ds_read_b128 v[20:23], v129 offset:8192
    ds_read_b64_tr_b16 v[36:37], v132 offset:43008
    v_mfma_f32_32x32x16_bf16 v[136:151], v[68:71], v[52:55], v[136:151]
    ds_read_b64_tr_b16 v[38:39], v132 offset:44544
    ds_read_b64_tr_b16 v[40:41], v132 offset:43136
    ds_read_b64_tr_b16 v[42:43], v132 offset:44672
    v_mfma_f32_32x32x16_bf16 v[152:167], v[72:75], v[52:55], v[152:167]
    ds_read_b64_tr_b16 v[44:45], v132 offset:43264
    ds_read_b64_tr_b16 v[46:47], v132 offset:44800
    v_mfma_f32_32x32x16_bf16 v[168:183], v[52:55], v[76:79], v[168:183]
    s_waitcnt lgkmcnt(0)
    s_barrier
    v_mfma_f32_32x32x16_bf16 v[136:151], v[24:27], v[16:19], v[136:151]
    ds_read_b128 v[48:51], v130 offset:8192
    ds_read_b64_tr_b16 v[56:57], v132 offset:49152
    ds_read_b64_tr_b16 v[58:59], v132 offset:50688
    v_mfma_f32_32x32x16_bf16 v[152:167], v[28:31], v[16:19], v[152:167]
    ds_read_b64_tr_b16 v[60:61], v132 offset:49280
    ds_read_b64_tr_b16 v[62:63], v132 offset:50816
    ds_read_b64_tr_b16 v[64:65], v132 offset:49408
    v_mfma_f32_32x32x16_bf16 v[168:183], v[16:19], v[32:35], v[168:183]
    ds_read_b64_tr_b16 v[66:67], v132 offset:50944
    ds_read_b128 v[52:55], v131 offset:8192
    ds_read_b64_tr_b16 v[68:69], v132 offset:55296
    v_mfma_f32_32x32x16_bf16 v[136:151], v[36:39], v[20:23], v[136:151]
    ds_read_b64_tr_b16 v[70:71], v132 offset:56832
    ds_read_b64_tr_b16 v[72:73], v132 offset:55424
    ds_read_b64_tr_b16 v[74:75], v132 offset:56960
    v_mfma_f32_32x32x16_bf16 v[152:167], v[40:43], v[20:23], v[152:167]
    ds_read_b64_tr_b16 v[76:77], v132 offset:55552
    ds_read_b64_tr_b16 v[78:79], v132 offset:57088
    v_mfma_f32_32x32x16_bf16 v[168:183], v[20:23], v[44:47], v[168:183]
    s_waitcnt lgkmcnt(0)
    s_barrier
    v_mfma_f32_32x32x16_bf16 v[136:151], v[56:59], v[48:51], v[136:151]
    ds_read_b128 v[16:19], v128 offset:16384
    ds_read_b64_tr_b16 v[24:25], v132 offset:0
    ds_read_b64_tr_b16 v[26:27], v132 offset:1536
    v_mfma_f32_32x32x16_bf16 v[152:167], v[60:63], v[48:51], v[152:167]
    ds_read_b64_tr_b16 v[28:29], v132 offset:128
    ds_read_b64_tr_b16 v[30:31], v132 offset:1664
    ds_read_b64_tr_b16 v[32:33], v132 offset:256
    v_mfma_f32_32x32x16_bf16 v[168:183], v[48:51], v[64:67], v[168:183]
    ds_read_b64_tr_b16 v[34:35], v132 offset:1792
    ds_read_b128 v[20:23], v129 offset:16384
    ds_read_b64_tr_b16 v[36:37], v132 offset:6144
    v_mfma_f32_32x32x16_bf16 v[136:151], v[68:71], v[52:55], v[136:151]
    ds_read_b64_tr_b16 v[38:39], v132 offset:7680
    ds_read_b64_tr_b16 v[40:41], v132 offset:6272
    ds_read_b64_tr_b16 v[42:43], v132 offset:7808
    v_mfma_f32_32x32x16_bf16 v[152:167], v[72:75], v[52:55], v[152:167]
    ds_read_b64_tr_b16 v[44:45], v132 offset:6400
    ds_read_b64_tr_b16 v[46:47], v132 offset:7936
    v_mfma_f32_32x32x16_bf16 v[168:183], v[52:55], v[76:79], v[168:183]
    s_waitcnt lgkmcnt(0)
    s_barrier
    v_mfma_f32_32x32x16_bf16 v[136:151], v[24:27], v[16:19], v[136:151]
    ds_read_b128 v[48:51], v130 offset:16384
    ds_read_b64_tr_b16 v[56:57], v132 offset:12288
    ds_read_b64_tr_b16 v[58:59], v132 offset:13824
    v_mfma_f32_32x32x16_bf16 v[152:167], v[28:31], v[16:19], v[152:167]
    ds_read_b64_tr_b16 v[60:61], v132 offset:12416
    ds_read_b64_tr_b16 v[62:63], v132 offset:13952
    ds_read_b64_tr_b16 v[64:65], v132 offset:12544
    v_mfma_f32_32x32x16_bf16 v[168:183], v[16:19], v[32:35], v[168:183]
    ds_read_b64_tr_b16 v[66:67], v132 offset:14080
    ds_read_b128 v[52:55], v131 offset:16384
    ds_read_b64_tr_b16 v[68:69], v132 offset:18432
    v_mfma_f32_32x32x16_bf16 v[136:151], v[36:39], v[20:23], v[136:151]
    ds_read_b64_tr_b16 v[70:71], v132 offset:19968
    ds_read_b64_tr_b16 v[72:73], v132 offset:18560
    ds_read_b64_tr_b16 v[74:75], v132 offset:20096
    v_mfma_f32_32x32x16_bf16 v[152:167], v[40:43], v[20:23], v[152:167]
    ds_read_b64_tr_b16 v[76:77], v132 offset:18688
    ds_read_b64_tr_b16 v[78:79], v132 offset:20224
    v_mfma_f32_32x32x16_bf16 v[168:183], v[20:23], v[44:47], v[168:183]
    s_waitcnt lgkmcnt(0)
    s_barrier
    v_mfma_f32_32x32x16_bf16 v[136:151], v[56:59], v[48:51], v[136:151]
    ds_read_b128 v[16:19], v128 offset:0
    ds_read_b64_tr_b16 v[24:25], v132 offset:24576
    ds_read_b64_tr_b16 v[26:27], v132 offset:26112
    v_mfma_f32_32x32x16_bf16 v[152:167], v[60:63], v[48:51], v[152:167]
    ds_read_b64_tr_b16 v[28:29], v132 offset:24704
    ds_read_b64_tr_b16 v[30:31], v132 offset:26240
    ds_read_b64_tr_b16 v[32:33], v132 offset:24832
    v_mfma_f32_32x32x16_bf16 v[168:183], v[48:51], v[64:67], v[168:183]
    ds_read_b64_tr_b16 v[34:35], v132 offset:26368
    ds_read_b128 v[20:23], v129 offset:0
    ds_read_b64_tr_b16 v[36:37], v132 offset:30720
    v_mfma_f32_32x32x16_bf16 v[136:151], v[68:71], v[52:55], v[136:151]
    ds_read_b64_tr_b16 v[38:39], v132 offset:32256
    ds_read_b64_tr_b16 v[40:41], v132 offset:30848
    ds_read_b64_tr_b16 v[42:43], v132 offset:32384
    v_mfma_f32_32x32x16_bf16 v[152:167], v[72:75], v[52:55], v[152:167]
    ds_read_b64_tr_b16 v[44:45], v132 offset:30976
    ds_read_b64_tr_b16 v[46:47], v132 offset:32512
    v_mfma_f32_32x32x16_bf16 v[168:183], v[52:55], v[76:79], v[168:183]
    s_waitcnt lgkmcnt(0)
    s_barrier
    v_mfma_f32_32x32x16_bf16 v[136:151], v[24:27], v[16:19], v[136:151]
    ds_read_b128 v[48:51], v130 offset:0
    ds_read_b64_tr_b16 v[56:57], v132 offset:36864
    ds_read_b64_tr_b16 v[58:59], v132 offset:38400
    v_mfma_f32_32x32x16_bf16 v[152:167], v[28:31], v[16:19], v[152:167]
    ds_read_b64_tr_b16 v[60:61], v132 offset:36992
    ds_read_b64_tr_b16 v[62:63], v132 offset:38528
    ds_read_b64_tr_b16 v[64:65], v132 offset:37120
    v_mfma_f32_32x32x16_bf16 v[168:183], v[16:19], v[32:35], v[168:183]
    ds_read_b64_tr_b16 v[66:67], v132 offset:38656
    ds_read_b128 v[52:55], v131 offset:0
    ds_read_b64_tr_b16 v[68:69], v132 offset:43008
    v_mfma_f32_32x32x16_bf16 v[136:151], v[36:39], v[20:23], v[136:151]
    ds_read_b64_tr_b16 v[70:71], v132 offset:44544
    ds_read_b64_tr_b16 v[72:73], v132 offset:43136
    ds_read_b64_tr_b16 v[74:75], v132 offset:44672
    v_mfma_f32_32x32x16_bf16 v[152:167], v[40:43], v[20:23], v[152:167]
    ds_read_b64_tr_b16 v[76:77], v132 offset:43264
    ds_read_b64_tr_b16 v[78:79], v132 offset:44800
    v_mfma_f32_32x32x16_bf16 v[168:183], v[20:23], v[44:47], v[168:183]
    s_waitcnt lgkmcnt(0)
    s_barrier
    v_mfma_f32_32x32x16_bf16 v[136:151], v[56:59], v[48:51], v[136:151]
    ds_read_b128 v[16:19], v128 offset:8192
    ds_read_b64_tr_b16 v[24:25], v132 offset:49152
    ds_read_b64_tr_b16 v[26:27], v132 offset:50688
    v_mfma_f32_32x32x16_bf16 v[152:167], v[60:63], v[48:51], v[152:167]
    ds_read_b64_tr_b16 v[28:29], v132 offset:49280
    ds_read_b64_tr_b16 v[30:31], v132 offset:50816
    ds_read_b64_tr_b16 v[32:33], v132 offset:49408
    v_mfma_f32_32x32x16_bf16 v[168:183], v[48:51], v[64:67], v[168:183]
    ds_read_b64_tr_b16 v[34:35], v132 offset:50944
    ds_read_b128 v[20:23], v129 offset:8192
    ds_read_b64_tr_b16 v[36:37], v132 offset:55296
    v_mfma_f32_32x32x16_bf16 v[136:151], v[68:71], v[52:55], v[136:151]
    ds_read_b64_tr_b16 v[38:39], v132 offset:56832
    ds_read_b64_tr_b16 v[40:41], v132 offset:55424
    ds_read_b64_tr_b16 v[42:43], v132 offset:56960
    v_mfma_f32_32x32x16_bf16 v[152:167], v[72:75], v[52:55], v[152:167]
    ds_read_b64_tr_b16 v[44:45], v132 offset:55552
    ds_read_b64_tr_b16 v[46:47], v132 offset:57088
    v_mfma_f32_32x32x16_bf16 v[168:183], v[52:55], v[76:79], v[168:183]
    s_waitcnt lgkmcnt(0)
    s_barrier
    v_mfma_f32_32x32x16_bf16 v[136:151], v[24:27], v[16:19], v[136:151]
    ds_read_b128 v[48:51], v130 offset:8192
    ds_read_b64_tr_b16 v[56:57], v132 offset:0
    ds_read_b64_tr_b16 v[58:59], v132 offset:1536
    v_mfma_f32_32x32x16_bf16 v[152:167], v[28:31], v[16:19], v[152:167]
    ds_read_b64_tr_b16 v[60:61], v132 offset:128
    ds_read_b64_tr_b16 v[62:63], v132 offset:1664
    ds_read_b64_tr_b16 v[64:65], v132 offset:256
    v_mfma_f32_32x32x16_bf16 v[168:183], v[16:19], v[32:35], v[168:183]
    ds_read_b64_tr_b16 v[66:67], v132 offset:1792
    ds_read_b128 v[52:55], v131 offset:8192
    ds_read_b64_tr_b16 v[68:69], v132 offset:6144
    v_mfma_f32_32x32x16_bf16 v[136:151], v[36:39], v[20:23], v[136:151]
    ds_read_b64_tr_b16 v[70:71], v132 offset:7680
    ds_read_b64_tr_b16 v[72:73], v132 offset:6272
    ds_read_b64_tr_b16 v[74:75], v132 offset:7808
    v_mfma_f32_32x32x16_bf16 v[152:167], v[40:43], v[20:23], v[152:167]
    ds_read_b64_tr_b16 v[76:77], v132 offset:6400
    ds_read_b64_tr_b16 v[78:79], v132 offset:7936
    v_mfma_f32_32x32x16_bf16 v[168:183], v[20:23], v[44:47], v[168:183]
    s_waitcnt lgkmcnt(0)
    v_mov_b32 v13, 162816
    ds_read_b32 v14, v13 offset:4
    ds_read_b32 v15, v13 offset:20
    v_mfma_f32_32x32x16_bf16 v[136:151], v[56:59], v[48:51], v[136:151]
    v_mfma_f32_32x32x16_bf16 v[152:167], v[60:63], v[48:51], v[152:167]
    v_mfma_f32_32x32x16_bf16 v[168:183], v[48:51], v[64:67], v[168:183]
    v_mfma_f32_32x32x16_bf16 v[152:167], v[72:75], v[52:55], v[152:167]
    v_mfma_f32_32x32x16_bf16 v[168:183], v[52:55], v[76:79], v[168:183]
    v_mfma_f32_32x32x16_bf16 v[136:151], v[68:71], v[52:55], v[136:151]
    s_waitcnt lgkmcnt(0)
    v_readfirstlane_b32 s66, v14
    v_readfirstlane_b32 s69, v15
    s_nop 0
    s_cmp_eq_u32 s69, 0
    s_cbranch_scc1 KF_STG
    s_nop 3
    v_cvt_pk_bf16_f32 v104, v152, v153
    v_cvt_pk_bf16_f32 v105, v154, v155
    v_cvt_pk_bf16_f32 v106, v156, v157
    v_cvt_pk_bf16_f32 v107, v158, v159
    v_cvt_pk_bf16_f32 v108, v160, v161
    v_cvt_pk_bf16_f32 v109, v162, v163
    v_cvt_pk_bf16_f32 v110, v164, v165
    v_cvt_pk_bf16_f32 v111, v166, v167
    buffer_store_dwordx4 v[104:107], v133, s[20:23], s50 offen
    buffer_store_dwordx4 v[108:111], v133, s[20:23], s51 offen
    v_cvt_pk_bf16_f32 v112, v168, v169
    v_cvt_pk_bf16_f32 v113, v170, v171
    v_cvt_pk_bf16_f32 v114, v172, v173
    v_cvt_pk_bf16_f32 v115, v174, v175
    v_cvt_pk_bf16_f32 v116, v176, v177
    v_cvt_pk_bf16_f32 v117, v178, v179
    v_cvt_pk_bf16_f32 v118, v180, v181
    v_cvt_pk_bf16_f32 v119, v182, v183
    v_permlane32_swap_b32 v112, v114
    v_permlane32_swap_b32 v113, v115
    v_permlane32_swap_b32 v116, v118
    v_permlane32_swap_b32 v117, v119
    buffer_store_dwordx4 v[112:115], v134, s[20:23], s52 offen
    buffer_store_dwordx4 v[116:119], v134, s[20:23], s52 offen offset:512
    v_mul_f32 v136, s58, v136
    v_mul_f32 v137, s58, v137
    v_mul_f32 v138, s58, v138
    v_mul_f32 v139, s58, v139
    v_mul_f32 v140, s58, v140
    v_mul_f32 v141, s58, v141
    v_mul_f32 v142, s58, v142
    v_mul_f32 v143, s58, v143
    v_mul_f32 v144, s58, v144
    v_mul_f32 v145, s58, v145
    v_mul_f32 v146, s58, v146
    v_mul_f32 v147, s58, v147
    v_mul_f32 v148, s58, v148
    v_mul_f32 v149, s58, v149
    v_mul_f32 v150, s58, v150
    v_mul_f32 v151, s58, v151
    v_cvt_pk_bf16_f32 v96, v136, v137
    v_cvt_pk_bf16_f32 v97, v138, v139
    v_cvt_pk_bf16_f32 v98, v140, v141
    v_cvt_pk_bf16_f32 v99, v142, v143
    v_cvt_pk_bf16_f32 v100, v144, v145
    v_cvt_pk_bf16_f32 v101, v146, v147
    v_cvt_pk_bf16_f32 v102, v148, v149
    v_cvt_pk_bf16_f32 v103, v150, v151
    buffer_store_dwordx4 v[96:99], v133, s[20:23], s33 offen
    buffer_store_dwordx4 v[100:103], v133, s[20:23], s34 offen
    s_branch KF_ATT0
KF_STG:
    s_nop 7
    s_nop 3
    v_cvt_pk_bf16_f32 v104, v152, v153
    v_cvt_pk_bf16_f32 v105, v154, v155
    v_cvt_pk_bf16_f32 v106, v156, v157
    v_cvt_pk_bf16_f32 v107, v158, v159
    v_cvt_pk_bf16_f32 v108, v160, v161
    v_cvt_pk_bf16_f32 v109, v162, v163
    v_cvt_pk_bf16_f32 v110, v164, v165
    v_cvt_pk_bf16_f32 v111, v166, v167
    buffer_store_dwordx4 v[104:107], v133, s[20:23], s50 offen sc1
    buffer_store_dwordx4 v[108:111], v133, s[20:23], s51 offen sc1
    v_cvt_pk_bf16_f32 v112, v168, v169
    v_cvt_pk_bf16_f32 v113, v170, v171
    v_cvt_pk_bf16_f32 v114, v172, v173
    v_cvt_pk_bf16_f32 v115, v174, v175
    v_cvt_pk_bf16_f32 v116, v176, v177
    v_cvt_pk_bf16_f32 v117, v178, v179
    v_cvt_pk_bf16_f32 v118, v180, v181
    v_cvt_pk_bf16_f32 v119, v182, v183
    v_permlane32_swap_b32 v112, v114
    v_permlane32_swap_b32 v113, v115
    v_permlane32_swap_b32 v116, v118
    v_permlane32_swap_b32 v117, v119
    buffer_store_dwordx4 v[112:115], v134, s[20:23], s52 offen sc1
    buffer_store_dwordx4 v[116:119], v134, s[20:23], s52 offen offset:512 sc1
    v_mul_f32 v136, s58, v136
    v_mul_f32 v137, s58, v137
    v_mul_f32 v138, s58, v138
    v_mul_f32 v139, s58, v139
    v_mul_f32 v140, s58, v140
    v_mul_f32 v141, s58, v141
    v_mul_f32 v142, s58, v142
    v_mul_f32 v143, s58, v143
    v_mul_f32 v144, s58, v144
    v_mul_f32 v145, s58, v145
    v_mul_f32 v146, s58, v146
    v_mul_f32 v147, s58, v147
    v_mul_f32 v148, s58, v148
    v_mul_f32 v149, s58, v149
    v_mul_f32 v150, s58, v150
    v_mul_f32 v151, s58, v151
    v_cvt_pk_bf16_f32 v96, v136, v137
    v_cvt_pk_bf16_f32 v97, v138, v139
    v_cvt_pk_bf16_f32 v98, v140, v141
    v_cvt_pk_bf16_f32 v99, v142, v143
    v_cvt_pk_bf16_f32 v100, v144, v145
    v_cvt_pk_bf16_f32 v101, v146, v147
    v_cvt_pk_bf16_f32 v102, v148, v149
    v_cvt_pk_bf16_f32 v103, v150, v151
    buffer_store_dwordx4 v[96:99], v133, s[20:23], s33 offen sc1
    buffer_store_dwordx4 v[100:103], v133, s[20:23], s34 offen sc1
    s_branch KF_ATT0
KF_LX:
    v_add_u32 v8, 0, v1
    v_mul_u32_u24 v9, 171, v8
    v_lshrrev_b32 v9, 12, v9
    v_mul_u32_u24 v10, 24, v9
    v_sub_u32 v10, v8, v10
    v_mul_u32_u24 v160, 3072, v9
    v_lshrrev_b32 v11, 3, v10
    v_lshl_add_u32 v160, v11, 10, v160
    v_lshlrev_b32 v11, 1, v9
    v_and_b32 v11, 4, v11
    v_xor_b32 v11, v11, v10
    v_and_b32 v11, 7, v11
    v_lshl_add_u32 v160, v11, 4, v160
    v_subrev_u32 v160, 0, v160
    v_add_u32 v8, 64, v1
    v_mul_u32_u24 v9, 171, v8
    v_lshrrev_b32 v9, 12, v9
    v_mul_u32_u24 v10, 24, v9
    v_sub_u32 v10, v8, v10
    v_mul_u32_u24 v161, 3072, v9
    v_lshrrev_b32 v11, 3, v10
    v_lshl_add_u32 v161, v11, 10, v161
    v_lshlrev_b32 v11, 1, v9
    v_and_b32 v11, 4, v11
    v_xor_b32 v11, v11, v10
    v_and_b32 v11, 7, v11
    v_lshl_add_u32 v161, v11, 4, v161
    v_subrev_u32 v161, 1024, v161
    v_add_u32 v8, 128, v1
    v_mul_u32_u24 v9, 171, v8
    v_lshrrev_b32 v9, 12, v9
    v_mul_u32_u24 v10, 24, v9
    v_sub_u32 v10, v8, v10
    v_mul_u32_u24 v162, 3072, v9
    v_lshrrev_b32 v11, 3, v10
    v_lshl_add_u32 v162, v11, 10, v162
    v_lshlrev_b32 v11, 1, v9
    v_and_b32 v11, 4, v11
    v_xor_b32 v11, v11, v10
    v_and_b32 v11, 7, v11
    v_lshl_add_u32 v162, v11, 4, v162
    v_subrev_u32 v162, 2048, v162
    v_lshrrev_b32 v163, 3, v1
    v_lshlrev_b32 v163, 10, v163
    v_lshrrev_b32 v8, 4, v1
    v_xor_b32 v8, v8, v1
    v_and_b32 v8, 7, v8
    v_lshl_add_u32 v163, v8, 4, v163
    v_xor_b32 v164, 64, v163
    v_add_u32 v164, 7168, v164
    v_add_u32 v165, 14336, v163
    v_add_u32 v166, 14336, v164
    v_lshrrev_b32 v169, 4, v1
    v_lshlrev_b32 v169, 16, v169
    v_and_b32 v8, 15, v1
    v_lshl_add_u32 v169, v8, 7, v169
    s_waitcnt lgkmcnt(0)
    s_mov_b32 s12, s4
    s_and_b32 s13, s5, 0xffff
    s_mov_b32 s16, s6
    s_and_b32 s17, s7, 0xffff
    s_mov_b32 s20, s10
    s_and_b32 s21, s11, 0xffff
    s_mov_b32 s60, s8
    s_and_b32 s61, s9, 0xffff
    s_setprio 3
    s_lshl_b32 s50, s26, 7
    s_lshr_b32 s52, s31, 3
    s_lshl_b32 s52, s52, 1
    s_add_u32 s52, s52, s31
    v_lshlrev_b32 v168, 10, v1
    s_lshr_b32 s56, s16, 7
    s_add_u32 s56, s56, s26
    s_and_b32 s56, s56, 7
    s_cmp_eq_u32 s56, 3
    s_cselect_b32 s56, 0, 0x40000000
    v_add_u32 v168, s56, v168
    s_lshl_b32 s51, s25, 16
    s_lshl_b32 s59, s26, 18
    s_lshl_b32 s56, s25, 11
    s_add_u32 s59, s59, s56
    s_barrier
    s_add_u32 s56, s52, 0
    s_and_b32 s56, s56, 7
    s_lshl_b32 s56, s56, 7
    s_add_u32 s56, s56, s51
    s_mov_b32 m0, 124928
    s_add_u32 s58, s56, 0
    buffer_load_dwordx4 v163, s[12:15], s58 offen offset:0 lds
    buffer_load_dwordx4 v164, s[12:15], s58 offen offset:1024 lds
    buffer_load_dwordx4 v165, s[12:15], s58 offen offset:2048 lds
    buffer_load_dwordx4 v166, s[12:15], s58 offen offset:3072 lds
    s_add_u32 s56, s52, 0
    s_and_b32 s56, s56, 7
    s_lshl_b32 s56, s56, 7
    s_add_u32 s56, s56, s51
    s_mov_b32 m0, 129024
    s_add_u32 s58, s56, 32768
    buffer_load_dwordx4 v163, s[12:15], s58 offen offset:0 lds
    buffer_load_dwordx4 v164, s[12:15], s58 offen offset:1024 lds
    buffer_load_dwordx4 v165, s[12:15], s58 offen offset:2048 lds
    buffer_load_dwordx4 v166, s[12:15], s58 offen offset:3072 lds
    s_add_u32 s56, s52, 0
    s_and_b32 s56, s56, 7
    s_mul_i32 s56, s56, 196608
    s_add_u32 s56, s56, s50
    s_mov_b32 m0, 63488
    s_add_u32 s57, s56, 0
    buffer_load_dwordx4 v160, s[16:19], s57 offen offset:0 lds
    buffer_load_dwordx4 v161, s[16:19], s57 offen offset:1024 lds
    buffer_load_dwordx4 v162, s[16:19], s57 offen offset:2048 lds
    s_add_u32 s56, s52, 0
    s_and_b32 s56, s56, 7
    s_mul_i32 s56, s56, 196608
    s_add_u32 s56, s56, s50
    s_mov_b32 m0, 75776
    s_add_u32 s57, s56, 98304
    buffer_load_dwordx4 v160, s[16:19], s57 offen offset:0 lds
    buffer_load_dwordx4 v161, s[16:19], s57 offen offset:1024 lds
    buffer_load_dwordx4 v162, s[16:19], s57 offen offset:2048 lds
    s_add_u32 s56, s52, 1
    s_and_b32 s56, s56, 7
    s_lshl_b32 s56, s56, 7
    s_add_u32 s56, s56, s51
    s_mov_b32 m0, 133120
    s_add_u32 s58, s56, 0
    buffer_load_dwordx4 v163, s[12:15], s58 offen offset:0 lds
    buffer_load_dwordx4 v164, s[12:15], s58 offen offset:1024 lds
    buffer_load_dwordx4 v165, s[12:15], s58 offen offset:2048 lds
    buffer_load_dwordx4 v166, s[12:15], s58 offen offset:3072 lds
    s_add_u32 s56, s52, 1
    s_and_b32 s56, s56, 7
    s_lshl_b32 s56, s56, 7
    s_add_u32 s56, s56, s51
    s_mov_b32 m0, 137216
    s_add_u32 s58, s56, 32768
    buffer_load_dwordx4 v163, s[12:15], s58 offen offset:0 lds
    buffer_load_dwordx4 v164, s[12:15], s58 offen offset:1024 lds
    buffer_load_dwordx4 v165, s[12:15], s58 offen offset:2048 lds
    buffer_load_dwordx4 v166, s[12:15], s58 offen offset:3072 lds
    s_setprio 0
    s_and_b32 s33, s24, 1
    s_bfe_u32 s34, s24, 0x10001
    v_and_b32 v8, 15, v1
    v_lshrrev_b32 v9, 4, v1
    v_lshlrev_b32 v10, 3, v9
    v_sub_u32 v10, v10, v8
    v_add_u32 v10, 2031, v10
    v_and_b32 v11, 3, v10
    v_and_b32 v10, -4, v10
    v_lshlrev_b32 v10, 1, v10
    v_mul_u32_u24 v11, 4160, v11
    v_add_u32 v10, v10, v11
    s_mul_i32 s64, s33, 32768
    s_add_u32 s64, s64, 12288
    v_lshlrev_b32 v222, 4, v1
    v_add_u32 v222, s64, v222
    s_lshl_b32 s70, s34, 8
    s_sub_u32 s64, s64, s70
    s_sub_u32 s64, s64, 3776
    v_add_u32 v218, s64, v10
    v_lshl_add_u32 v220, v8, 1, v9
    v_lshlrev_b32 v220, 4, v220
    s_mul_i32 s64, s33, 6144
    s_add_u32 s64, s64, 149792
    s_sub_u32 s64, s64, s70
    v_add_u32 v220, s64, v220
    s_mul_i32 s64, s24, 4224
    s_add_u32 s64, s64, 65536
    v_lshlrev_b32 v221, 4, v1
    v_add_u32 v221, s64, v221
    s_xor_b32 s64, s24, 2
    s_mul_i32 s64, s64, 4224
    s_add_u32 s64, s64, 65536
    v_lshlrev_b32 v216, 4, v1
    v_add_u32 v216, s64, v216
    s_lshl_b32 s70, s3, 1
    s_add_u32 s70, s70, s33
    s_lshl_b32 s70, s70, 12
    s_lshl_b32 s64, s34, 11
    s_add_u32 s70, s70, s64
    s_add_u32 s70, s70, 15728640
    v_lshlrev_b32 v217, 5, v8
    v_lshl_add_u32 v217, v9, 3, v217
    s_lshl_b32 s64, s24, 2
    s_add_u32 s64, s64, 162832
    v_mov_b32 v223, s64
    v_or_b32 v230, 8, v223
    s_mul_i32 s64, s33, 32768
    v_sub_u32 v137, 63, v1
    v_lshlrev_b32 v137, 2, v137
    v_add_u32 v137, s64, v137
    v_and_b32 v138, 1, v1
    v_xor_b32 v138, 1, v138
    v_lshl_add_u32 v138, v138, 2, v137
    s_load_dwordx2 s[40:41], s[0:1], 16
    s_load_dwordx2 s[42:43], s[0:1], 104
    s_lshl_b32 s44, s25, 10
    s_lshl_b32 s45, s26, 5
    s_add_u32 s44, s44, s45
    s_add_u32 s44, s44, 18055168
    s_lshl_b32 s45, s3, 5
    s_add_u32 s45, s45, 18022400
    s_and_b32 s25, s2, 7
    s_lshl_b32 s25, s25, 2
    s_bfe_u32 s26, s2, 0x20003
    s_add_u32 s25, s25, s26
    s_lshr_b32 s26, s2, 5
    s_lshl_b32 s27, s25, 16
    s_and_b32 s36, s24, 3
    s_lshr_b32 s37, s24, 2
    s_lshl_b32 s28, s26, 3
    s_lshl_b32 s29, s36, 1
    s_add_u32 s28, s28, s29
    v_lshlrev_b32 v7, 4, v1
    s_lshl_b32 s30, s37, 5
    s_add_u32 s30, s30, s36
    s_mul_i32 s38, s30, 1056
    s_add_u32 s38, s38, 65536
    s_lshl_b32 s30, s30, 10
    s_add_u32 s31, s27, s30
    s_add_u32 s32, s31, 4194304
    s_add_u32 s31, s31, 2097152
    s_mov_b32 s46, 0
    v_and_b32 v177, 31, v1
    v_lshrrev_b32 v178, 5, v1
    s_lshl_b32 s53, s37, 15
    v_add_u32 v2, s53, v7
    s_mul_i32 s53, s37, 33792
    s_add_u32 s53, s53, 65536
    v_lshlrev_b32 v179, 8, v178
    v_and_b32 v182, 15, v1
    v_lshl_add_u32 v179, v182, 4, v179
    v_and_b32 v182, 27, v1
    v_cmp_eq_u32 vcc, 16, v182
    v_mov_b32 v182, 1040
    v_mov_b32 v183, 1024
    v_cndmask_b32 v182, v182, v183, vcc
    v_cmp_gt_u32 vcc, 16, v177
    v_subrev_u32 v183, 512, v182
    v_lshrrev_b32 v5, 3, v1
    v_cndmask_b32 v3, v182, v179, vcc
    v_cndmask_b32 v4, v183, v179, vcc
    v_add_u32 v3, s53, v3
    v_add_u32 v4, s53, v4
    v_bfe_u32 v182, v1, 4, 1
    v_lshlrev_b32 v182, 2, v182
    v_xor_b32 v182, v182, v1
    v_and_b32 v182, 7, v182
    v_lshlrev_b32 v6, 12, v5
    v_lshlrev_b32 v5, 10, v5
    v_lshl_add_u32 v5, v182, 4, v5
    v_lshl_add_u32 v6, v182, 4, v6
    s_lshl_b32 s53, s26, 10
    s_add_u32 s53, s53, 18022400
    s_lshl_b32 s54, s25, 10
    s_add_u32 s54, s54, 18055168
    v_lshlrev_b32 v182, 5, v177
    v_add_u32 v182, s53, v182
    v_and_b32 v183, 7, v1
    v_lshlrev_b32 v183, 5, v183
    v_add_u32 v183, s54, v183
    v_cmp_gt_u32 vcc, 32, v1
    v_lshlrev_b32 v229, 2, v1
    v_lshlrev_b32 v241, 2, v1
    v_add_u32 v245, 2097152, v7
    v_and_b32 v246, 0x7c, v229
    v_lshlrev_b32 v242, 2, v1
    s_lshl_b32 s47, s24, 10
    v_cndmask_b32 v227, v183, v182, vcc
    s_lshl_b32 s48, s24, 13
    s_lshl_b32 s49, s26, 7
    s_add_u32 s48, s48, s49
    s_mov_b32 s49, 0
    s_and_b32 s53, s24, 1
    v_lshrrev_b32 v176, 4, v1
    v_bfe_u32 v177, v1, 2, 2
    v_lshrrev_b32 v178, 1, v176
    v_lshlrev_b32 v178, 4, v178
    v_and_b32 v179, 1, v176
    v_lshl_add_u32 v178, v179, 2, v178
    v_add_u32 v178, v178, v177
    v_lshlrev_b32 v178, 7, v178
    v_lshrrev_b32 v179, 1, v177
    v_lshlrev_b32 v179, 6, v179
    v_and_b32 v180, 3, v1
    v_lshlrev_b32 v180, 3, v180
    s_lshr_b32 s54, s24, 1
    s_lshl_b32 s54, s54, 5
    v_add_u32 v232, s54, v180
    v_xor_b32 v232, v232, v179
    v_add_u32 v232, v232, v178
    v_lshl_add_u32 v233, v176, 2, v177
    v_lshlrev_b32 v233, 7, v233
    s_lshl_b32 s54, s53, 6
    v_add_u32 v181, s54, v180
    v_xor_b32 v181, v181, v179
    v_add_u32 v233, v233, v181
    s_lshr_b32 s54, s24, 1
    s_lshl_b32 s54, s54, 11
    s_add_u32 s54, s54, 133120
    v_add_u32 v233, s54, v233
    v_lshlrev_b32 v234, 9, v176
    v_and_b32 v181, 15, v1
    v_lshl_add_u32 v234, v181, 4, v234
    s_lshl_b32 s54, s53, 12
    v_add_u32 v234, s54, v234
    v_add_u32 v235, 82432, v234
    v_lshlrev_b32 v236, 10, v181
    v_lshl_add_u32 v236, v176, 3, v236
    s_mul_i32 s53, s24, 2176
    s_add_u32 s53, s53, 145408
    s_xor_b32 s54, s24, 4
    s_mul_i32 s54, s54, 2176
    s_add_u32 s54, s54, 145408
    v_add_u32 v237, s53, v7
    v_add_u32 v238, s54, v7
    v_and_b32 v239, 0x7c, v229
    v_add_u32 v240, s54, v239
    v_add_u32 v239, s53, v239
    s_waitcnt lgkmcnt(0)
    s_mov_b32 s4, s40
    s_and_b32 s5, s41, 0xffff
    s_mov_b32 s6, 0x80000
    s_mov_b32 s7, 0x00020000
    s_mov_b32 s8, s42
    s_and_b32 s9, s43, 0xffff
    s_mov_b32 s10, 0x200000
    s_mov_b32 s11, 0x00020000
    s_add_u32 s30, s30, 4096
    s_add_u32 s31, s31, 4096
    s_add_u32 s32, s32, 4096
    s_add_u32 s38, s38, 4224
    v_mov_b32 v56, 0
    v_mov_b32 v57, 0
    v_mov_b32 v58, 0
    v_mov_b32 v59, 0
    v_mov_b32 v60, 0
    v_mov_b32 v61, 0
    v_mov_b32 v62, 0
    v_mov_b32 v63, 0
    v_mov_b32 v64, 0
    v_mov_b32 v65, 0
    v_mov_b32 v66, 0
    v_mov_b32 v67, 0
    v_mov_b32 v68, 0
    v_mov_b32 v69, 0
    v_mov_b32 v70, 0
    v_mov_b32 v71, 0
    v_mov_b32 v72, 0
    v_mov_b32 v73, 0
    v_mov_b32 v74, 0
    v_mov_b32 v75, 0
    v_mov_b32 v76, 0
    v_mov_b32 v77, 0
    v_mov_b32 v78, 0
    v_mov_b32 v79, 0
    v_mov_b32 v80, 0
    v_mov_b32 v81, 0
    v_mov_b32 v82, 0
    v_mov_b32 v83, 0
    v_mov_b32 v84, 0
    v_mov_b32 v85, 0
    v_mov_b32 v86, 0
    v_mov_b32 v87, 0
    v_mov_b32 v52, 0
    v_mov_b32 v53, 0
    v_mov_b32 v54, 0
    v_mov_b32 v55, 0
    v_mov_b32 v108, 0
    v_mov_b32 v109, 0
    v_mov_b32 v110, 0
    v_mov_b32 v111, 0
    s_setprio 3
    s_add_u32 s56, s52, 1
    s_and_b32 s56, s56, 7
    s_mul_i32 s56, s56, 196608
    s_add_u32 s56, s56, s50
    s_mov_b32 m0, 88064
    s_add_u32 s57, s56, 0
    buffer_load_dwordx4 v160, s[16:19], s57 offen offset:0 lds
    buffer_load_dwordx4 v161, s[16:19], s57 offen offset:1024 lds
    buffer_load_dwordx4 v162, s[16:19], s57 offen offset:2048 lds
    s_add_u32 s56, s52, 1
    s_and_b32 s56, s56, 7
    s_mul_i32 s56, s56, 196608
    s_add_u32 s56, s56, s50
    s_mov_b32 m0, 100352
    s_add_u32 s57, s56, 98304
    buffer_load_dwordx4 v160, s[16:19], s57 offen offset:0 lds
    buffer_load_dwordx4 v161, s[16:19], s57 offen offset:1024 lds
    buffer_load_dwordx4 v162, s[16:19], s57 offen offset:2048 lds
    s_waitcnt vmcnt(17)
    s_barrier
    s_add_u32 s56, s52, 2
    s_and_b32 s56, s56, 7
    s_lshl_b32 s56, s56, 7
    s_add_u32 s56, s56, s51
    s_mov_b32 m0, 141312
    s_add_u32 s58, s56, 0
    buffer_load_dwordx4 v163, s[12:15], s58 offen offset:0 lds
    buffer_load_dwordx4 v164, s[12:15], s58 offen offset:1024 lds
    buffer_load_dwordx4 v165, s[12:15], s58 offen offset:2048 lds
    buffer_load_dwordx4 v166, s[12:15], s58 offen offset:3072 lds
    s_add_u32 s56, s52, 2
    s_and_b32 s56, s56, 7
    s_mul_i32 s56, s56, 196608
    s_add_u32 s56, s56, s50
    s_mov_b32 m0, 112640
    s_add_u32 s57, s56, 0
    buffer_load_dwordx4 v160, s[16:19], s57 offen offset:0 lds
    buffer_load_dwordx4 v161, s[16:19], s57 offen offset:1024 lds
    buffer_load_dwordx4 v162, s[16:19], s57 offen offset:2048 lds
    s_waitcnt vmcnt(21)
    s_barrier
    s_add_u32 s56, s52, 2
    s_and_b32 s56, s56, 7
    s_lshl_b32 s56, s56, 7
    s_add_u32 s56, s56, s51
    s_mov_b32 m0, 145408
    s_add_u32 s58, s56, 32768
    buffer_load_dwordx4 v163, s[12:15], s58 offen offset:0 lds
    buffer_load_dwordx4 v164, s[12:15], s58 offen offset:1024 lds
    buffer_load_dwordx4 v165, s[12:15], s58 offen offset:2048 lds
    buffer_load_dwordx4 v166, s[12:15], s58 offen offset:3072 lds
    s_add_u32 s56, s52, 2
    s_and_b32 s56, s56, 7
    s_mul_i32 s56, s56, 196608
    s_add_u32 s56, s56, s50
    s_mov_b32 m0, 63488
    s_add_u32 s57, s56, 98304
    buffer_load_dwordx4 v160, s[16:19], s57 offen offset:0 lds
    buffer_load_dwordx4 v161, s[16:19], s57 offen offset:1024 lds
    buffer_load_dwordx4 v162, s[16:19], s57 offen offset:2048 lds
    s_waitcnt vmcnt(17)
    s_barrier
    s_add_u32 s56, s52, 3
    s_and_b32 s56, s56, 7
    s_lshl_b32 s56, s56, 7
    s_add_u32 s56, s56, s51
    s_mov_b32 m0, 124928
    s_add_u32 s58, s56, 0
    buffer_load_dwordx4 v163, s[12:15], s58 offen offset:0 lds
    buffer_load_dwordx4 v164, s[12:15], s58 offen offset:1024 lds
    buffer_load_dwordx4 v165, s[12:15], s58 offen offset:2048 lds
    buffer_load_dwordx4 v166, s[12:15], s58 offen offset:3072 lds
    s_add_u32 s56, s52, 3
    s_and_b32 s56, s56, 7
    s_mul_i32 s56, s56, 196608
    s_add_u32 s56, s56, s50
    s_mov_b32 m0, 75776
    s_add_u32 s57, s56, 0
    buffer_load_dwordx4 v160, s[16:19], s57 offen offset:0 lds
    buffer_load_dwordx4 v161, s[16:19], s57 offen offset:1024 lds
    buffer_load_dwordx4 v162, s[16:19], s57 offen offset:2048 lds
    s_waitcnt vmcnt(21)
    s_barrier
    s_add_u32 s56, s52, 3
    s_and_b32 s56, s56, 7
    s_lshl_b32 s56, s56, 7
    s_add_u32 s56, s56, s51
    s_mov_b32 m0, 129024
    s_add_u32 s58, s56, 32768
    buffer_load_dwordx4 v163, s[12:15], s58 offen offset:0 lds
    buffer_load_dwordx4 v164, s[12:15], s58 offen offset:1024 lds
    buffer_load_dwordx4 v165, s[12:15], s58 offen offset:2048 lds
    buffer_load_dwordx4 v166, s[12:15], s58 offen offset:3072 lds
    s_add_u32 s56, s52, 3
    s_and_b32 s56, s56, 7
    s_mul_i32 s56, s56, 196608
    s_add_u32 s56, s56, s50
    s_mov_b32 m0, 88064
    s_add_u32 s57, s56, 98304
    buffer_load_dwordx4 v160, s[16:19], s57 offen offset:0 lds
    buffer_load_dwordx4 v161, s[16:19], s57 offen offset:1024 lds
    buffer_load_dwordx4 v162, s[16:19], s57 offen offset:2048 lds
    s_waitcnt vmcnt(17)
    s_barrier
    s_add_u32 s56, s52, 4
    s_and_b32 s56, s56, 7
    s_lshl_b32 s56, s56, 7
    s_add_u32 s56, s56, s51
    s_mov_b32 m0, 133120
    s_add_u32 s58, s56, 0
    buffer_load_dwordx4 v163, s[12:15], s58 offen offset:0 lds
    buffer_load_dwordx4 v164, s[12:15], s58 offen offset:1024 lds
    buffer_load_dwordx4 v165, s[12:15], s58 offen offset:2048 lds
    buffer_load_dwordx4 v166, s[12:15], s58 offen offset:3072 lds
    s_add_u32 s56, s52, 4
    s_and_b32 s56, s56, 7
    s_mul_i32 s56, s56, 196608
    s_add_u32 s56, s56, s50
    s_mov_b32 m0, 100352
    s_add_u32 s57, s56, 0
    buffer_load_dwordx4 v160, s[16:19], s57 offen offset:0 lds
    buffer_load_dwordx4 v161, s[16:19], s57 offen offset:1024 lds
    buffer_load_dwordx4 v162, s[16:19], s57 offen offset:2048 lds
    s_waitcnt vmcnt(21)
    s_barrier
    s_add_u32 s56, s52, 4
    s_and_b32 s56, s56, 7
    s_lshl_b32 s56, s56, 7
    s_add_u32 s56, s56, s51
    s_mov_b32 m0, 137216
    s_add_u32 s58, s56, 32768
    buffer_load_dwordx4 v163, s[12:15], s58 offen offset:0 lds
    buffer_load_dwordx4 v164, s[12:15], s58 offen offset:1024 lds
    buffer_load_dwordx4 v165, s[12:15], s58 offen offset:2048 lds
    buffer_load_dwordx4 v166, s[12:15], s58 offen offset:3072 lds
    s_add_u32 s56, s52, 4
    s_and_b32 s56, s56, 7
    s_mul_i32 s56, s56, 196608
    s_add_u32 s56, s56, s50
    s_mov_b32 m0, 112640
    s_add_u32 s57, s56, 98304
    buffer_load_dwordx4 v160, s[16:19], s57 offen offset:0 lds
    buffer_load_dwordx4 v161, s[16:19], s57 offen offset:1024 lds
    buffer_load_dwordx4 v162, s[16:19], s57 offen offset:2048 lds
    s_waitcnt vmcnt(17)
    s_barrier
    s_add_u32 s56, s52, 5
    s_and_b32 s56, s56, 7
    s_lshl_b32 s56, s56, 7
    s_add_u32 s56, s56, s51
    s_mov_b32 m0, 141312
    s_add_u32 s58, s56, 0
    buffer_load_dwordx4 v163, s[12:15], s58 offen offset:0 lds
    buffer_load_dwordx4 v164, s[12:15], s58 offen offset:1024 lds
    buffer_load_dwordx4 v165, s[12:15], s58 offen offset:2048 lds
    buffer_load_dwordx4 v166, s[12:15], s58 offen offset:3072 lds
    s_add_u32 s56, s52, 5
    s_and_b32 s56, s56, 7
    s_mul_i32 s56, s56, 196608
    s_add_u32 s56, s56, s50
    s_mov_b32 m0, 63488
    s_add_u32 s57, s56, 0
    buffer_load_dwordx4 v160, s[16:19], s57 offen offset:0 lds
    buffer_load_dwordx4 v161, s[16:19], s57 offen offset:1024 lds
    buffer_load_dwordx4 v162, s[16:19], s57 offen offset:2048 lds
    s_waitcnt vmcnt(21)
    s_barrier
    s_add_u32 s56, s52, 5
    s_and_b32 s56, s56, 7
    s_lshl_b32 s56, s56, 7
    s_add_u32 s56, s56, s51
    s_mov_b32 m0, 145408
    s_add_u32 s58, s56, 32768
    buffer_load_dwordx4 v163, s[12:15], s58 offen offset:0 lds
    buffer_load_dwordx4 v164, s[12:15], s58 offen offset:1024 lds
    buffer_load_dwordx4 v165, s[12:15], s58 offen offset:2048 lds
    buffer_load_dwordx4 v166, s[12:15], s58 offen offset:3072 lds
    s_add_u32 s56, s52, 5
    s_and_b32 s56, s56, 7
    s_mul_i32 s56, s56, 196608
    s_add_u32 s56, s56, s50
    s_mov_b32 m0, 75776
    s_add_u32 s57, s56, 98304
    buffer_load_dwordx4 v160, s[16:19], s57 offen offset:0 lds
    buffer_load_dwordx4 v161, s[16:19], s57 offen offset:1024 lds
    buffer_load_dwordx4 v162, s[16:19], s57 offen offset:2048 lds
    s_waitcnt vmcnt(17)
    s_barrier
    s_add_u32 s56, s52, 6
    s_and_b32 s56, s56, 7
    s_lshl_b32 s56, s56, 7
    s_add_u32 s56, s56, s51
    s_mov_b32 m0, 124928
    s_add_u32 s58, s56, 0
    buffer_load_dwordx4 v163, s[12:15], s58 offen offset:0 lds
    buffer_load_dwordx4 v164, s[12:15], s58 offen offset:1024 lds
    buffer_load_dwordx4 v165, s[12:15], s58 offen offset:2048 lds
    buffer_load_dwordx4 v166, s[12:15], s58 offen offset:3072 lds
    s_add_u32 s56, s52, 6
    s_and_b32 s56, s56, 7
    s_mul_i32 s56, s56, 196608
    s_add_u32 s56, s56, s50
    s_mov_b32 m0, 88064
    s_add_u32 s57, s56, 0
    buffer_load_dwordx4 v160, s[16:19], s57 offen offset:0 lds
    buffer_load_dwordx4 v161, s[16:19], s57 offen offset:1024 lds
    buffer_load_dwordx4 v162, s[16:19], s57 offen offset:2048 lds
    s_waitcnt vmcnt(21)
    s_barrier
    s_add_u32 s56, s52, 6
    s_and_b32 s56, s56, 7
    s_lshl_b32 s56, s56, 7
    s_add_u32 s56, s56, s51
    s_mov_b32 m0, 129024
    s_add_u32 s58, s56, 32768
    buffer_load_dwordx4 v163, s[12:15], s58 offen offset:0 lds
    buffer_load_dwordx4 v164, s[12:15], s58 offen offset:1024 lds
    buffer_load_dwordx4 v165, s[12:15], s58 offen offset:2048 lds
    buffer_load_dwordx4 v166, s[12:15], s58 offen offset:3072 lds
    s_add_u32 s56, s52, 6
    s_and_b32 s56, s56, 7
    s_mul_i32 s56, s56, 196608
    s_add_u32 s56, s56, s50
    s_mov_b32 m0, 100352
    s_add_u32 s57, s56, 98304
    buffer_load_dwordx4 v160, s[16:19], s57 offen offset:0 lds
    buffer_load_dwordx4 v161, s[16:19], s57 offen offset:1024 lds
    buffer_load_dwordx4 v162, s[16:19], s57 offen offset:2048 lds
    s_waitcnt vmcnt(17)
    s_barrier
    s_add_u32 s56, s52, 7
    s_and_b32 s56, s56, 7
    s_lshl_b32 s56, s56, 7
    s_add_u32 s56, s56, s51
    s_mov_b32 m0, 133120
    s_add_u32 s58, s56, 0
    buffer_load_dwordx4 v163, s[12:15], s58 offen offset:0 lds
    buffer_load_dwordx4 v164, s[12:15], s58 offen offset:1024 lds
    buffer_load_dwordx4 v165, s[12:15], s58 offen offset:2048 lds
    buffer_load_dwordx4 v166, s[12:15], s58 offen offset:3072 lds
    s_add_u32 s56, s52, 7
    s_and_b32 s56, s56, 7
    s_mul_i32 s56, s56, 196608
    s_add_u32 s56, s56, s50
    s_mov_b32 m0, 112640
    s_add_u32 s57, s56, 0
    buffer_load_dwordx4 v160, s[16:19], s57 offen offset:0 lds
    buffer_load_dwordx4 v161, s[16:19], s57 offen offset:1024 lds
    buffer_load_dwordx4 v162, s[16:19], s57 offen offset:2048 lds
    s_waitcnt vmcnt(21)
    s_barrier
    s_add_u32 s56, s52, 7
    s_and_b32 s56, s56, 7
    s_lshl_b32 s56, s56, 7
    s_add_u32 s56, s56, s51
    s_mov_b32 m0, 137216
    s_add_u32 s58, s56, 32768
    buffer_load_dwordx4 v163, s[12:15], s58 offen offset:0 lds
    buffer_load_dwordx4 v164, s[12:15], s58 offen offset:1024 lds
    buffer_load_dwordx4 v165, s[12:15], s58 offen offset:2048 lds
    buffer_load_dwordx4 v166, s[12:15], s58 offen offset:3072 lds
    s_add_u32 s56, s52, 7
    s_and_b32 s56, s56, 7
    s_mul_i32 s56, s56, 196608
    s_add_u32 s56, s56, s50
    s_mov_b32 m0, 63488
    s_add_u32 s57, s56, 98304
    buffer_load_dwordx4 v160, s[16:19], s57 offen offset:0 lds
    buffer_load_dwordx4 v161, s[16:19], s57 offen offset:1024 lds
    buffer_load_dwordx4 v162, s[16:19], s57 offen offset:2048 lds
    s_waitcnt vmcnt(17)
    s_barrier
    s_add_u32 s56, s59, 2097152
    s_add_u32 s57, s59, 4194304
    s_bfe_u32 s58, s2, 0x40003
    s_cmp_lt_u32 s58, 4
    s_cselect_b32 s56, s56, s59
    s_cselect_b32 s57, s57, s59
    buffer_load_dword v225, v169, s[20:23], s59 offen sc1
    buffer_load_dword v225, v169, s[20:23], s56 offen sc1
    buffer_load_dword v225, v169, s[20:23], s57 offen sc1
    s_waitcnt vmcnt(17)
    s_barrier
    s_waitcnt vmcnt(6)
    s_barrier
    s_setprio 0
    v_mov_b32 v14, 0
    v_mov_b32 v15, 0
    v_lshlrev_b32 v13, 3, v1
    v_add_u32 v13, 149504, v13
    ds_write_b64 v13, v[14:15]
    s_waitcnt vmcnt(3)
    s_barrier
    v_mov_b32 v13, 162820
    ds_read_b32 v13, v13
    ds_read_b32 v20, v137 offset:264
    ds_read_b32 v21, v137 offset:4996
    ds_read_b32 v22, v137 offset:260
    ds_read_b32 v23, v137 offset:4
    ds_read_b32 v24, v137 offset:1188
    ds_read_b32 v25, v137 offset:2372
    ds_read_b32 v26, v137 offset:3556
    ds_read_b32 v27, v137 offset:4740
    ds_read_b32 v28, v137 offset:5924
    ds_read_b32 v29, v137 offset:7108
    ds_read_b32 v30, v137 offset:8292
    ds_read_b32 v31, v137 offset:8
    s_waitcnt lgkmcnt(0)
    v_cvt_pk_bf16_f32 v160, v20, v20
    v_cvt_pk_bf16_f32 v161, v21, v21
    v_cvt_pk_bf16_f32 v162, v21, v22
    v_cvt_pk_bf16_f32 v163, v22, v22
    ds_write_b128 v222, v[160:163] offset:2048
    s_mov_b32 exec_hi, 0
    v_mov_b32 v30, v31
    v_mov_b32 v28, v27
    v_mov_b32 v26, v27
    v_mov_b32 v24, v23
    s_mov_b64 exec, -1
    v_cvt_pk_bf16_f32 v168, v30, v29
    v_cvt_pk_bf16_f32 v169, v28, v27
    v_cvt_pk_bf16_f32 v170, v26, v25
    v_cvt_pk_bf16_f32 v171, v24, v23
    ds_write_b128 v222, v[168:171] offset:3072
    ds_read_b64 v[164:165], v222 offset:2064
    ds_read_b64 v[172:173], v222 offset:3088
    s_waitcnt lgkmcnt(1)
    v_alignbit_b32 v112, v161, v160, 16
    v_alignbit_b32 v113, v162, v161, 16
    v_alignbit_b32 v114, v163, v162, 16
    v_alignbit_b32 v115, v164, v163, 16
    ds_write_b128 v222, v[112:115] offset:6208
    v_mov_b32 v116, v161
    v_mov_b32 v117, v162
    v_mov_b32 v118, v163
    v_mov_b32 v119, v164
    ds_write_b128 v222, v[116:119] offset:10368
    v_alignbit_b32 v120, v162, v161, 16
    v_alignbit_b32 v121, v163, v162, 16
    v_alignbit_b32 v122, v164, v163, 16
    v_alignbit_b32 v123, v165, v164, 16
    ds_write_b128 v222, v[120:123] offset:14528
    s_waitcnt lgkmcnt(3)
    v_alignbit_b32 v124, v169, v168, 16
    v_alignbit_b32 v125, v170, v169, 16
    v_alignbit_b32 v126, v171, v170, 16
    v_alignbit_b32 v127, v172, v171, 16
    ds_write_b128 v222, v[124:127] offset:7232
    v_mov_b32 v128, v169
    v_mov_b32 v129, v170
    v_mov_b32 v130, v171
    v_mov_b32 v131, v172
    ds_write_b128 v222, v[128:131] offset:11392
    v_alignbit_b32 v132, v170, v169, 16
    v_alignbit_b32 v133, v171, v170, 16
    v_alignbit_b32 v134, v172, v171, 16
    v_alignbit_b32 v135, v173, v172, 16
    ds_write_b128 v222, v[132:135] offset:15552
    v_readfirstlane_b32 s66, v13
    s_waitcnt lgkmcnt(0)
    s_barrier
    s_branch KF_CONV
KF_LW:
    v_add_u32 v8, 0, v1
    v_mul_u32_u24 v9, 171, v8
    v_lshrrev_b32 v9, 12, v9
    v_mul_u32_u24 v10, 24, v9
    v_sub_u32 v10, v8, v10
    v_mul_u32_u24 v160, 3072, v9
    v_lshrrev_b32 v11, 3, v10
    v_lshl_add_u32 v160, v11, 10, v160
    v_lshlrev_b32 v11, 1, v9
    v_and_b32 v11, 4, v11
    v_xor_b32 v11, v11, v10
    v_and_b32 v11, 7, v11
    v_lshl_add_u32 v160, v11, 4, v160
    v_subrev_u32 v160, 0, v160
    v_add_u32 v8, 64, v1
    v_mul_u32_u24 v9, 171, v8
    v_lshrrev_b32 v9, 12, v9
    v_mul_u32_u24 v10, 24, v9
    v_sub_u32 v10, v8, v10
    v_mul_u32_u24 v161, 3072, v9
    v_lshrrev_b32 v11, 3, v10
    v_lshl_add_u32 v161, v11, 10, v161
    v_lshlrev_b32 v11, 1, v9
    v_and_b32 v11, 4, v11
    v_xor_b32 v11, v11, v10
    v_and_b32 v11, 7, v11
    v_lshl_add_u32 v161, v11, 4, v161
    v_subrev_u32 v161, 1024, v161
    v_add_u32 v8, 128, v1
    v_mul_u32_u24 v9, 171, v8
    v_lshrrev_b32 v9, 12, v9
    v_mul_u32_u24 v10, 24, v9
    v_sub_u32 v10, v8, v10
    v_mul_u32_u24 v162, 3072, v9
    v_lshrrev_b32 v11, 3, v10
    v_lshl_add_u32 v162, v11, 10, v162
    v_lshlrev_b32 v11, 1, v9
    v_and_b32 v11, 4, v11
    v_xor_b32 v11, v11, v10
    v_and_b32 v11, 7, v11
    v_lshl_add_u32 v162, v11, 4, v162
    v_subrev_u32 v162, 2048, v162
    s_waitcnt lgkmcnt(0)
    s_mov_b32 s12, s4
    s_and_b32 s13, s5, 0xffff
    s_mov_b32 s16, s6
    s_and_b32 s17, s7, 0xffff
    s_mov_b32 s20, s10
    s_and_b32 s21, s11, 0xffff
    s_mov_b32 s60, s8
    s_and_b32 s61, s9, 0xffff
    s_setprio 3
    s_lshl_b32 s50, s26, 7
    s_lshr_b32 s52, s31, 3
    s_lshl_b32 s52, s52, 1
    s_add_u32 s52, s52, s31
    s_barrier
    s_add_u32 s56, s52, 0
    s_and_b32 s56, s56, 7
    s_mul_i32 s56, s56, 196608
    s_add_u32 s56, s56, s50
    s_mov_b32 m0, 66560
    s_add_u32 s58, s56, 24576
    buffer_load_dwordx4 v160, s[16:19], s58 offen offset:0 lds
    buffer_load_dwordx4 v161, s[16:19], s58 offen offset:1024 lds
    buffer_load_dwordx4 v162, s[16:19], s58 offen offset:2048 lds
    s_mov_b32 m0, 69632
    s_add_u32 s57, s56, 49152
    buffer_load_dwordx4 v160, s[16:19], s57 offen offset:0 lds
    buffer_load_dwordx4 v161, s[16:19], s57 offen offset:1024 lds
    buffer_load_dwordx4 v162, s[16:19], s57 offen offset:2048 lds
    s_mov_b32 m0, 72704
    s_add_u32 s58, s56, 73728
    buffer_load_dwordx4 v160, s[16:19], s58 offen offset:0 lds
    buffer_load_dwordx4 v161, s[16:19], s58 offen offset:1024 lds
    buffer_load_dwordx4 v162, s[16:19], s58 offen offset:2048 lds
    s_add_u32 s56, s52, 0
    s_and_b32 s56, s56, 7
    s_mul_i32 s56, s56, 196608
    s_add_u32 s56, s56, s50
    s_mov_b32 m0, 78848
    s_add_u32 s58, s56, 122880
    buffer_load_dwordx4 v160, s[16:19], s58 offen offset:0 lds
    buffer_load_dwordx4 v161, s[16:19], s58 offen offset:1024 lds
    buffer_load_dwordx4 v162, s[16:19], s58 offen offset:2048 lds
    s_mov_b32 m0, 81920
    s_add_u32 s57, s56, 147456
    buffer_load_dwordx4 v160, s[16:19], s57 offen offset:0 lds
    buffer_load_dwordx4 v161, s[16:19], s57 offen offset:1024 lds
    buffer_load_dwordx4 v162, s[16:19], s57 offen offset:2048 lds
    s_mov_b32 m0, 84992
    s_add_u32 s58, s56, 172032
    buffer_load_dwordx4 v160, s[16:19], s58 offen offset:0 lds
    buffer_load_dwordx4 v161, s[16:19], s58 offen offset:1024 lds
    buffer_load_dwordx4 v162, s[16:19], s58 offen offset:2048 lds
    s_setprio 0
    s_and_b32 s33, s24, 1
    s_bfe_u32 s34, s24, 0x10001
    v_and_b32 v8, 15, v1
    v_lshrrev_b32 v9, 4, v1
    v_lshlrev_b32 v10, 3, v9
    v_sub_u32 v10, v10, v8
    v_add_u32 v10, 2031, v10
    v_and_b32 v11, 3, v10
    v_and_b32 v10, -4, v10
    v_lshlrev_b32 v10, 1, v10
    v_mul_u32_u24 v11, 4160, v11
    v_add_u32 v10, v10, v11
    s_mul_i32 s64, s33, 32768
    s_add_u32 s64, s64, 12288
    v_lshlrev_b32 v222, 4, v1
    v_add_u32 v222, s64, v222
    s_lshl_b32 s70, s34, 8
    s_sub_u32 s64, s64, s70
    s_sub_u32 s64, s64, 3776
    v_add_u32 v218, s64, v10
    v_lshl_add_u32 v220, v8, 1, v9
    v_lshlrev_b32 v220, 4, v220
    s_mul_i32 s64, s33, 6144
    s_add_u32 s64, s64, 149792
    s_sub_u32 s64, s64, s70
    v_add_u32 v220, s64, v220
    s_mul_i32 s64, s24, 4224
    s_add_u32 s64, s64, 65536
    v_lshlrev_b32 v221, 4, v1
    v_add_u32 v221, s64, v221
    s_xor_b32 s64, s24, 2
    s_mul_i32 s64, s64, 4224
    s_add_u32 s64, s64, 65536
    v_lshlrev_b32 v216, 4, v1
    v_add_u32 v216, s64, v216
    s_lshl_b32 s70, s3, 1
    s_add_u32 s70, s70, s33
    s_lshl_b32 s70, s70, 12
    s_lshl_b32 s64, s34, 11
    s_add_u32 s70, s70, s64
    s_add_u32 s70, s70, 15728640
    v_lshlrev_b32 v217, 5, v8
    v_lshl_add_u32 v217, v9, 3, v217
    s_lshl_b32 s64, s24, 2
    s_add_u32 s64, s64, 162832
    v_mov_b32 v223, s64
    v_or_b32 v230, 8, v223
    s_mul_i32 s64, s33, 32768
    v_sub_u32 v137, 63, v1
    v_lshlrev_b32 v137, 2, v137
    v_add_u32 v137, s64, v137
    v_and_b32 v138, 1, v1
    v_xor_b32 v138, 1, v138
    v_lshl_add_u32 v138, v138, 2, v137
    s_load_dwordx2 s[40:41], s[0:1], 16
    s_load_dwordx2 s[42:43], s[0:1], 104
    s_lshl_b32 s44, s25, 10
    s_lshl_b32 s45, s26, 5
    s_add_u32 s44, s44, s45
    s_add_u32 s44, s44, 18055168
    s_lshl_b32 s45, s3, 5
    s_add_u32 s45, s45, 18022400
    s_and_b32 s25, s2, 7
    s_lshl_b32 s25, s25, 2
    s_bfe_u32 s26, s2, 0x20003
    s_add_u32 s25, s25, s26
    s_lshr_b32 s26, s2, 5
    s_lshl_b32 s27, s25, 16
    s_and_b32 s36, s24, 3
    s_lshr_b32 s37, s24, 2
    s_lshl_b32 s28, s26, 3
    s_lshl_b32 s29, s36, 1
    s_add_u32 s28, s28, s29
    v_lshlrev_b32 v7, 4, v1
    s_lshl_b32 s30, s37, 5
    s_add_u32 s30, s30, s36
    s_mul_i32 s38, s30, 1056
    s_add_u32 s38, s38, 65536
    s_lshl_b32 s30, s30, 10
    s_add_u32 s31, s27, s30
    s_add_u32 s32, s31, 4194304
    s_add_u32 s31, s31, 2097152
    s_mov_b32 s46, 0
    v_and_b32 v177, 31, v1
    v_lshrrev_b32 v178, 5, v1
    s_lshl_b32 s53, s37, 15
    v_add_u32 v2, s53, v7
    s_mul_i32 s53, s37, 33792
    s_add_u32 s53, s53, 65536
    v_lshlrev_b32 v179, 8, v178
    v_and_b32 v182, 15, v1
    v_lshl_add_u32 v179, v182, 4, v179
    v_and_b32 v182, 27, v1
    v_cmp_eq_u32 vcc, 16, v182
    v_mov_b32 v182, 1040
    v_mov_b32 v183, 1024
    v_cndmask_b32 v182, v182, v183, vcc
    v_cmp_gt_u32 vcc, 16, v177
    v_subrev_u32 v183, 512, v182
    v_lshrrev_b32 v5, 3, v1
    v_cndmask_b32 v3, v182, v179, vcc
    v_cndmask_b32 v4, v183, v179, vcc
    v_add_u32 v3, s53, v3
    v_add_u32 v4, s53, v4
    v_bfe_u32 v182, v1, 4, 1
    v_lshlrev_b32 v182, 2, v182
    v_xor_b32 v182, v182, v1
    v_and_b32 v182, 7, v182
    v_lshlrev_b32 v6, 12, v5
    v_lshlrev_b32 v5, 10, v5
    v_lshl_add_u32 v5, v182, 4, v5
    v_lshl_add_u32 v6, v182, 4, v6
    s_lshl_b32 s53, s26, 10
    s_add_u32 s53, s53, 18022400
    s_lshl_b32 s54, s25, 10
    s_add_u32 s54, s54, 18055168
    v_lshlrev_b32 v182, 5, v177
    v_add_u32 v182, s53, v182
    v_and_b32 v183, 7, v1
    v_lshlrev_b32 v183, 5, v183
    v_add_u32 v183, s54, v183
    v_cmp_gt_u32 vcc, 32, v1
    v_lshlrev_b32 v229, 2, v1
    v_lshlrev_b32 v241, 2, v1
    v_add_u32 v245, 2097152, v7
    v_and_b32 v246, 0x7c, v229
    v_lshlrev_b32 v242, 2, v1
    s_lshl_b32 s47, s24, 10
    v_cndmask_b32 v227, v183, v182, vcc
    s_lshl_b32 s48, s24, 13
    s_lshl_b32 s49, s26, 7
    s_add_u32 s48, s48, s49
    s_mov_b32 s49, 0
    s_and_b32 s53, s24, 1
    v_lshrrev_b32 v176, 4, v1
    v_bfe_u32 v177, v1, 2, 2
    v_lshrrev_b32 v178, 1, v176
    v_lshlrev_b32 v178, 4, v178
    v_and_b32 v179, 1, v176
    v_lshl_add_u32 v178, v179, 2, v178
    v_add_u32 v178, v178, v177
    v_lshlrev_b32 v178, 7, v178
    v_lshrrev_b32 v179, 1, v177
    v_lshlrev_b32 v179, 6, v179
    v_and_b32 v180, 3, v1
    v_lshlrev_b32 v180, 3, v180
    s_lshr_b32 s54, s24, 1
    s_lshl_b32 s54, s54, 5
    v_add_u32 v232, s54, v180
    v_xor_b32 v232, v232, v179
    v_add_u32 v232, v232, v178
    v_lshl_add_u32 v233, v176, 2, v177
    v_lshlrev_b32 v233, 7, v233
    s_lshl_b32 s54, s53, 6
    v_add_u32 v181, s54, v180
    v_xor_b32 v181, v181, v179
    v_add_u32 v233, v233, v181
    s_lshr_b32 s54, s24, 1
    s_lshl_b32 s54, s54, 11
    s_add_u32 s54, s54, 133120
    v_add_u32 v233, s54, v233
    v_lshlrev_b32 v234, 9, v176
    v_and_b32 v181, 15, v1
    v_lshl_add_u32 v234, v181, 4, v234
    s_lshl_b32 s54, s53, 12
    v_add_u32 v234, s54, v234
    v_add_u32 v235, 82432, v234
    v_lshlrev_b32 v236, 10, v181
    v_lshl_add_u32 v236, v176, 3, v236
    s_mul_i32 s53, s24, 2176
    s_add_u32 s53, s53, 145408
    s_xor_b32 s54, s24, 4
    s_mul_i32 s54, s54, 2176
    s_add_u32 s54, s54, 145408
    v_add_u32 v237, s53, v7
    v_add_u32 v238, s54, v7
    v_and_b32 v239, 0x7c, v229
    v_add_u32 v240, s54, v239
    v_add_u32 v239, s53, v239
    s_waitcnt lgkmcnt(0)
    s_mov_b32 s4, s40
    s_and_b32 s5, s41, 0xffff
    s_mov_b32 s6, 0x80000
    s_mov_b32 s7, 0x00020000
    s_mov_b32 s8, s42
    s_and_b32 s9, s43, 0xffff
    s_mov_b32 s10, 0x200000
    s_mov_b32 s11, 0x00020000
    s_add_u32 s30, s30, 4096
    s_add_u32 s31, s31, 4096
    s_add_u32 s32, s32, 4096
    s_add_u32 s38, s38, 4224
    v_mov_b32 v56, 0
    v_mov_b32 v57, 0
    v_mov_b32 v58, 0
    v_mov_b32 v59, 0
    v_mov_b32 v60, 0
    v_mov_b32 v61, 0
    v_mov_b32 v62, 0
    v_mov_b32 v63, 0
    v_mov_b32 v64, 0
    v_mov_b32 v65, 0
    v_mov_b32 v66, 0
    v_mov_b32 v67, 0
    v_mov_b32 v68, 0
    v_mov_b32 v69, 0
    v_mov_b32 v70, 0
    v_mov_b32 v71, 0
    v_mov_b32 v72, 0
    v_mov_b32 v73, 0
    v_mov_b32 v74, 0
    v_mov_b32 v75, 0
    v_mov_b32 v76, 0
    v_mov_b32 v77, 0
    v_mov_b32 v78, 0
    v_mov_b32 v79, 0
    v_mov_b32 v80, 0
    v_mov_b32 v81, 0
    v_mov_b32 v82, 0
    v_mov_b32 v83, 0
    v_mov_b32 v84, 0
    v_mov_b32 v85, 0
    v_mov_b32 v86, 0
    v_mov_b32 v87, 0
    v_mov_b32 v52, 0
    v_mov_b32 v53, 0
    v_mov_b32 v54, 0
    v_mov_b32 v55, 0
    v_mov_b32 v108, 0
    v_mov_b32 v109, 0
    v_mov_b32 v110, 0
    v_mov_b32 v111, 0
    s_setprio 3
    s_add_u32 s56, s52, 1
    s_and_b32 s56, s56, 7
    s_mul_i32 s56, s56, 196608
    s_add_u32 s56, s56, s50
    s_mov_b32 m0, 91136
    s_add_u32 s58, s56, 24576
    buffer_load_dwordx4 v160, s[16:19], s58 offen offset:0 lds
    buffer_load_dwordx4 v161, s[16:19], s58 offen offset:1024 lds
    buffer_load_dwordx4 v162, s[16:19], s58 offen offset:2048 lds
    s_mov_b32 m0, 94208
    s_add_u32 s57, s56, 49152
    buffer_load_dwordx4 v160, s[16:19], s57 offen offset:0 lds
    buffer_load_dwordx4 v161, s[16:19], s57 offen offset:1024 lds
    buffer_load_dwordx4 v162, s[16:19], s57 offen offset:2048 lds
    s_mov_b32 m0, 97280
    s_add_u32 s58, s56, 73728
    buffer_load_dwordx4 v160, s[16:19], s58 offen offset:0 lds
    buffer_load_dwordx4 v161, s[16:19], s58 offen offset:1024 lds
    buffer_load_dwordx4 v162, s[16:19], s58 offen offset:2048 lds
    s_add_u32 s56, s52, 1
    s_and_b32 s56, s56, 7
    s_mul_i32 s56, s56, 196608
    s_add_u32 s56, s56, s50
    s_mov_b32 m0, 103424
    s_add_u32 s58, s56, 122880
    buffer_load_dwordx4 v160, s[16:19], s58 offen offset:0 lds
    buffer_load_dwordx4 v161, s[16:19], s58 offen offset:1024 lds
    buffer_load_dwordx4 v162, s[16:19], s58 offen offset:2048 lds
    s_mov_b32 m0, 106496
    s_add_u32 s57, s56, 147456
    buffer_load_dwordx4 v160, s[16:19], s57 offen offset:0 lds
    buffer_load_dwordx4 v161, s[16:19], s57 offen offset:1024 lds
    buffer_load_dwordx4 v162, s[16:19], s57 offen offset:2048 lds
    s_mov_b32 m0, 109568
    s_add_u32 s58, s56, 172032
    buffer_load_dwordx4 v160, s[16:19], s58 offen offset:0 lds
    buffer_load_dwordx4 v161, s[16:19], s58 offen offset:1024 lds
    buffer_load_dwordx4 v162, s[16:19], s58 offen offset:2048 lds
    s_waitcnt vmcnt(27)
    s_barrier
    s_add_u32 s56, s52, 2
    s_and_b32 s56, s56, 7
    s_mul_i32 s56, s56, 196608
    s_add_u32 s56, s56, s50
    s_mov_b32 m0, 115712
    s_add_u32 s58, s56, 24576
    buffer_load_dwordx4 v160, s[16:19], s58 offen offset:0 lds
    buffer_load_dwordx4 v161, s[16:19], s58 offen offset:1024 lds
    buffer_load_dwordx4 v162, s[16:19], s58 offen offset:2048 lds
    s_mov_b32 m0, 118784
    s_add_u32 s57, s56, 49152
    buffer_load_dwordx4 v160, s[16:19], s57 offen offset:0 lds
    buffer_load_dwordx4 v161, s[16:19], s57 offen offset:1024 lds
    buffer_load_dwordx4 v162, s[16:19], s57 offen offset:2048 lds
    s_mov_b32 m0, 121856
    s_add_u32 s58, s56, 73728
    buffer_load_dwordx4 v160, s[16:19], s58 offen offset:0 lds
    buffer_load_dwordx4 v161, s[16:19], s58 offen offset:1024 lds
    buffer_load_dwordx4 v162, s[16:19], s58 offen offset:2048 lds
    s_waitcnt vmcnt(27)
    s_barrier
    s_add_u32 s56, s52, 2
    s_and_b32 s56, s56, 7
    s_mul_i32 s56, s56, 196608
    s_add_u32 s56, s56, s50
    s_mov_b32 m0, 66560
    s_add_u32 s58, s56, 122880
    buffer_load_dwordx4 v160, s[16:19], s58 offen offset:0 lds
    buffer_load_dwordx4 v161, s[16:19], s58 offen offset:1024 lds
    buffer_load_dwordx4 v162, s[16:19], s58 offen offset:2048 lds
    s_mov_b32 m0, 69632
    s_add_u32 s57, s56, 147456
    buffer_load_dwordx4 v160, s[16:19], s57 offen offset:0 lds
    buffer_load_dwordx4 v161, s[16:19], s57 offen offset:1024 lds
    buffer_load_dwordx4 v162, s[16:19], s57 offen offset:2048 lds
    s_mov_b32 m0, 72704
    s_add_u32 s58, s56, 172032
    buffer_load_dwordx4 v160, s[16:19], s58 offen offset:0 lds
    buffer_load_dwordx4 v161, s[16:19], s58 offen offset:1024 lds
    buffer_load_dwordx4 v162, s[16:19], s58 offen offset:2048 lds
    s_waitcnt vmcnt(27)
    s_barrier
    s_add_u32 s56, s52, 3
    s_and_b32 s56, s56, 7
    s_mul_i32 s56, s56, 196608
    s_add_u32 s56, s56, s50
    s_mov_b32 m0, 78848
    s_add_u32 s58, s56, 24576
    buffer_load_dwordx4 v160, s[16:19], s58 offen offset:0 lds
    buffer_load_dwordx4 v161, s[16:19], s58 offen offset:1024 lds
    buffer_load_dwordx4 v162, s[16:19], s58 offen offset:2048 lds
    s_mov_b32 m0, 81920
    s_add_u32 s57, s56, 49152
    buffer_load_dwordx4 v160, s[16:19], s57 offen offset:0 lds
    buffer_load_dwordx4 v161, s[16:19], s57 offen offset:1024 lds
    buffer_load_dwordx4 v162, s[16:19], s57 offen offset:2048 lds
    s_mov_b32 m0, 84992
    s_add_u32 s58, s56, 73728
    buffer_load_dwordx4 v160, s[16:19], s58 offen offset:0 lds
    buffer_load_dwordx4 v161, s[16:19], s58 offen offset:1024 lds
    buffer_load_dwordx4 v162, s[16:19], s58 offen offset:2048 lds
    s_waitcnt vmcnt(27)
    s_barrier
    s_add_u32 s56, s52, 3
    s_and_b32 s56, s56, 7
    s_mul_i32 s56, s56, 196608
    s_add_u32 s56, s56, s50
    s_mov_b32 m0, 91136
    s_add_u32 s58, s56, 122880
    buffer_load_dwordx4 v160, s[16:19], s58 offen offset:0 lds
    buffer_load_dwordx4 v161, s[16:19], s58 offen offset:1024 lds
    buffer_load_dwordx4 v162, s[16:19], s58 offen offset:2048 lds
    s_mov_b32 m0, 94208
    s_add_u32 s57, s56, 147456
    buffer_load_dwordx4 v160, s[16:19], s57 offen offset:0 lds
    buffer_load_dwordx4 v161, s[16:19], s57 offen offset:1024 lds
    buffer_load_dwordx4 v162, s[16:19], s57 offen offset:2048 lds
    s_mov_b32 m0, 97280
    s_add_u32 s58, s56, 172032
    buffer_load_dwordx4 v160, s[16:19], s58 offen offset:0 lds
    buffer_load_dwordx4 v161, s[16:19], s58 offen offset:1024 lds
    buffer_load_dwordx4 v162, s[16:19], s58 offen offset:2048 lds
    s_waitcnt vmcnt(27)
    s_barrier
    s_add_u32 s56, s52, 4
    s_and_b32 s56, s56, 7
    s_mul_i32 s56, s56, 196608
    s_add_u32 s56, s56, s50
    s_mov_b32 m0, 103424
    s_add_u32 s58, s56, 24576
    buffer_load_dwordx4 v160, s[16:19], s58 offen offset:0 lds
    buffer_load_dwordx4 v161, s[16:19], s58 offen offset:1024 lds
    buffer_load_dwordx4 v162, s[16:19], s58 offen offset:2048 lds
    s_mov_b32 m0, 106496
    s_add_u32 s57, s56, 49152
    buffer_load_dwordx4 v160, s[16:19], s57 offen offset:0 lds
    buffer_load_dwordx4 v161, s[16:19], s57 offen offset:1024 lds
    buffer_load_dwordx4 v162, s[16:19], s57 offen offset:2048 lds
    s_mov_b32 m0, 109568
    s_add_u32 s58, s56, 73728
    buffer_load_dwordx4 v160, s[16:19], s58 offen offset:0 lds
    buffer_load_dwordx4 v161, s[16:19], s58 offen offset:1024 lds
    buffer_load_dwordx4 v162, s[16:19], s58 offen offset:2048 lds
    s_waitcnt vmcnt(27)
    s_barrier
    s_add_u32 s56, s52, 4
    s_and_b32 s56, s56, 7
    s_mul_i32 s56, s56, 196608
    s_add_u32 s56, s56, s50
    s_mov_b32 m0, 115712
    s_add_u32 s58, s56, 122880
    buffer_load_dwordx4 v160, s[16:19], s58 offen offset:0 lds
    buffer_load_dwordx4 v161, s[16:19], s58 offen offset:1024 lds
    buffer_load_dwordx4 v162, s[16:19], s58 offen offset:2048 lds
    s_mov_b32 m0, 118784
    s_add_u32 s57, s56, 147456
    buffer_load_dwordx4 v160, s[16:19], s57 offen offset:0 lds
    buffer_load_dwordx4 v161, s[16:19], s57 offen offset:1024 lds
    buffer_load_dwordx4 v162, s[16:19], s57 offen offset:2048 lds
    s_mov_b32 m0, 121856
    s_add_u32 s58, s56, 172032
    buffer_load_dwordx4 v160, s[16:19], s58 offen offset:0 lds
    buffer_load_dwordx4 v161, s[16:19], s58 offen offset:1024 lds
    buffer_load_dwordx4 v162, s[16:19], s58 offen offset:2048 lds
    s_waitcnt vmcnt(27)
    s_barrier
    s_add_u32 s56, s52, 5
    s_and_b32 s56, s56, 7
    s_mul_i32 s56, s56, 196608
    s_add_u32 s56, s56, s50
    s_mov_b32 m0, 66560
    s_add_u32 s58, s56, 24576
    buffer_load_dwordx4 v160, s[16:19], s58 offen offset:0 lds
    buffer_load_dwordx4 v161, s[16:19], s58 offen offset:1024 lds
    buffer_load_dwordx4 v162, s[16:19], s58 offen offset:2048 lds
    s_mov_b32 m0, 69632
    s_add_u32 s57, s56, 49152
    buffer_load_dwordx4 v160, s[16:19], s57 offen offset:0 lds
    buffer_load_dwordx4 v161, s[16:19], s57 offen offset:1024 lds
    buffer_load_dwordx4 v162, s[16:19], s57 offen offset:2048 lds
    s_mov_b32 m0, 72704
    s_add_u32 s58, s56, 73728
    buffer_load_dwordx4 v160, s[16:19], s58 offen offset:0 lds
    buffer_load_dwordx4 v161, s[16:19], s58 offen offset:1024 lds
    buffer_load_dwordx4 v162, s[16:19], s58 offen offset:2048 lds
    s_waitcnt vmcnt(27)
    s_barrier
    s_add_u32 s56, s52, 5
    s_and_b32 s56, s56, 7
    s_mul_i32 s56, s56, 196608
    s_add_u32 s56, s56, s50
    s_mov_b32 m0, 78848
    s_add_u32 s58, s56, 122880
    buffer_load_dwordx4 v160, s[16:19], s58 offen offset:0 lds
    buffer_load_dwordx4 v161, s[16:19], s58 offen offset:1024 lds
    buffer_load_dwordx4 v162, s[16:19], s58 offen offset:2048 lds
    s_mov_b32 m0, 81920
    s_add_u32 s57, s56, 147456
    buffer_load_dwordx4 v160, s[16:19], s57 offen offset:0 lds
    buffer_load_dwordx4 v161, s[16:19], s57 offen offset:1024 lds
    buffer_load_dwordx4 v162, s[16:19], s57 offen offset:2048 lds
    s_mov_b32 m0, 84992
    s_add_u32 s58, s56, 172032
    buffer_load_dwordx4 v160, s[16:19], s58 offen offset:0 lds
    buffer_load_dwordx4 v161, s[16:19], s58 offen offset:1024 lds
    buffer_load_dwordx4 v162, s[16:19], s58 offen offset:2048 lds
    s_waitcnt vmcnt(27)
    s_barrier
    s_add_u32 s56, s52, 6
    s_and_b32 s56, s56, 7
    s_mul_i32 s56, s56, 196608
    s_add_u32 s56, s56, s50
    s_mov_b32 m0, 91136
    s_add_u32 s58, s56, 24576
    buffer_load_dwordx4 v160, s[16:19], s58 offen offset:0 lds
    buffer_load_dwordx4 v161, s[16:19], s58 offen offset:1024 lds
    buffer_load_dwordx4 v162, s[16:19], s58 offen offset:2048 lds
    s_mov_b32 m0, 94208
    s_add_u32 s57, s56, 49152
    buffer_load_dwordx4 v160, s[16:19], s57 offen offset:0 lds
    buffer_load_dwordx4 v161, s[16:19], s57 offen offset:1024 lds
    buffer_load_dwordx4 v162, s[16:19], s57 offen offset:2048 lds
    s_mov_b32 m0, 97280
    s_add_u32 s58, s56, 73728
    buffer_load_dwordx4 v160, s[16:19], s58 offen offset:0 lds
    buffer_load_dwordx4 v161, s[16:19], s58 offen offset:1024 lds
    buffer_load_dwordx4 v162, s[16:19], s58 offen offset:2048 lds
    s_waitcnt vmcnt(27)
    s_barrier
    s_add_u32 s56, s52, 6
    s_and_b32 s56, s56, 7
    s_mul_i32 s56, s56, 196608
    s_add_u32 s56, s56, s50
    s_mov_b32 m0, 103424
    s_add_u32 s58, s56, 122880
    buffer_load_dwordx4 v160, s[16:19], s58 offen offset:0 lds
    buffer_load_dwordx4 v161, s[16:19], s58 offen offset:1024 lds
    buffer_load_dwordx4 v162, s[16:19], s58 offen offset:2048 lds
    s_mov_b32 m0, 106496
    s_add_u32 s57, s56, 147456
    buffer_load_dwordx4 v160, s[16:19], s57 offen offset:0 lds
    buffer_load_dwordx4 v161, s[16:19], s57 offen offset:1024 lds
    buffer_load_dwordx4 v162, s[16:19], s57 offen offset:2048 lds
    s_mov_b32 m0, 109568
    s_add_u32 s58, s56, 172032
    buffer_load_dwordx4 v160, s[16:19], s58 offen offset:0 lds
    buffer_load_dwordx4 v161, s[16:19], s58 offen offset:1024 lds
    buffer_load_dwordx4 v162, s[16:19], s58 offen offset:2048 lds
    s_waitcnt vmcnt(27)
    s_barrier
    s_add_u32 s56, s52, 7
    s_and_b32 s56, s56, 7
    s_mul_i32 s56, s56, 196608
    s_add_u32 s56, s56, s50
    s_mov_b32 m0, 115712
    s_add_u32 s58, s56, 24576
    buffer_load_dwordx4 v160, s[16:19], s58 offen offset:0 lds
    buffer_load_dwordx4 v161, s[16:19], s58 offen offset:1024 lds
    buffer_load_dwordx4 v162, s[16:19], s58 offen offset:2048 lds
    s_mov_b32 m0, 118784
    s_add_u32 s57, s56, 49152
    buffer_load_dwordx4 v160, s[16:19], s57 offen offset:0 lds
    buffer_load_dwordx4 v161, s[16:19], s57 offen offset:1024 lds
    buffer_load_dwordx4 v162, s[16:19], s57 offen offset:2048 lds
    s_mov_b32 m0, 121856
    s_add_u32 s58, s56, 73728
    buffer_load_dwordx4 v160, s[16:19], s58 offen offset:0 lds
    buffer_load_dwordx4 v161, s[16:19], s58 offen offset:1024 lds
    buffer_load_dwordx4 v162, s[16:19], s58 offen offset:2048 lds
    s_waitcnt vmcnt(27)
    s_barrier
    s_add_u32 s56, s52, 7
    s_and_b32 s56, s56, 7
    s_mul_i32 s56, s56, 196608
    s_add_u32 s56, s56, s50
    s_mov_b32 m0, 66560
    s_add_u32 s58, s56, 122880
    buffer_load_dwordx4 v160, s[16:19], s58 offen offset:0 lds
    buffer_load_dwordx4 v161, s[16:19], s58 offen offset:1024 lds
    buffer_load_dwordx4 v162, s[16:19], s58 offen offset:2048 lds
    s_mov_b32 m0, 69632
    s_add_u32 s57, s56, 147456
    buffer_load_dwordx4 v160, s[16:19], s57 offen offset:0 lds
    buffer_load_dwordx4 v161, s[16:19], s57 offen offset:1024 lds
    buffer_load_dwordx4 v162, s[16:19], s57 offen offset:2048 lds
    s_mov_b32 m0, 72704
    s_add_u32 s58, s56, 172032
    buffer_load_dwordx4 v160, s[16:19], s58 offen offset:0 lds
    buffer_load_dwordx4 v161, s[16:19], s58 offen offset:1024 lds
    buffer_load_dwordx4 v162, s[16:19], s58 offen offset:2048 lds
    s_waitcnt vmcnt(27)
    s_barrier
    s_waitcnt vmcnt(18)
    s_barrier
    s_waitcnt vmcnt(9)
    s_barrier
    s_setprio 0
    v_mov_b32 v14, 0
    v_mov_b32 v15, 0
    v_lshlrev_b32 v13, 3, v1
    v_add_u32 v13, 155648, v13
    ds_write_b64 v13, v[14:15]
    s_waitcnt vmcnt(0)
    s_barrier
    v_mov_b32 v13, 162820
    ds_read_b32 v13, v13
    ds_read_b32 v20, v137 offset:264
    ds_read_b32 v21, v137 offset:4996
    ds_read_b32 v22, v137 offset:260
    ds_read_b32 v23, v137 offset:4
    ds_read_b32 v24, v137 offset:1188
    ds_read_b32 v25, v137 offset:2372
    ds_read_b32 v26, v137 offset:3556
    ds_read_b32 v27, v137 offset:4740
    ds_read_b32 v28, v137 offset:5924
    ds_read_b32 v29, v137 offset:7108
    ds_read_b32 v30, v137 offset:8292
    ds_read_b32 v31, v137 offset:8
    s_waitcnt lgkmcnt(0)
    v_cvt_pk_bf16_f32 v160, v20, v20
    v_cvt_pk_bf16_f32 v161, v21, v21
    v_cvt_pk_bf16_f32 v162, v21, v22
    v_cvt_pk_bf16_f32 v163, v22, v22
    ds_write_b128 v222, v[160:163] offset:2048
    s_mov_b32 exec_hi, 0
    v_mov_b32 v30, v31
    v_mov_b32 v28, v27
    v_mov_b32 v26, v27
    v_mov_b32 v24, v23
    s_mov_b64 exec, -1
    v_cvt_pk_bf16_f32 v168, v30, v29
    v_cvt_pk_bf16_f32 v169, v28, v27
    v_cvt_pk_bf16_f32 v170, v26, v25
    v_cvt_pk_bf16_f32 v171, v24, v23
    ds_write_b128 v222, v[168:171] offset:3072
    ds_read_b64 v[164:165], v222 offset:2064
    ds_read_b64 v[172:173], v222 offset:3088
    s_waitcnt lgkmcnt(1)
    v_alignbit_b32 v112, v161, v160, 16
    v_alignbit_b32 v113, v162, v161, 16
    v_alignbit_b32 v114, v163, v162, 16
    v_alignbit_b32 v115, v164, v163, 16
    ds_write_b128 v222, v[112:115] offset:6208
    v_mov_b32 v116, v161
    v_mov_b32 v117, v162
    v_mov_b32 v118, v163
    v_mov_b32 v119, v164
    ds_write_b128 v222, v[116:119] offset:10368
    v_alignbit_b32 v120, v162, v161, 16
    v_alignbit_b32 v121, v163, v162, 16
    v_alignbit_b32 v122, v164, v163, 16
    v_alignbit_b32 v123, v165, v164, 16
    ds_write_b128 v222, v[120:123] offset:14528
    s_waitcnt lgkmcnt(3)
    v_alignbit_b32 v124, v169, v168, 16
    v_alignbit_b32 v125, v170, v169, 16
    v_alignbit_b32 v126, v171, v170, 16
    v_alignbit_b32 v127, v172, v171, 16
    ds_write_b128 v222, v[124:127] offset:7232
    v_mov_b32 v128, v169
    v_mov_b32 v129, v170
    v_mov_b32 v130, v171
    v_mov_b32 v131, v172
    ds_write_b128 v222, v[128:131] offset:11392
    v_alignbit_b32 v132, v170, v169, 16
    v_alignbit_b32 v133, v171, v170, 16
    v_alignbit_b32 v134, v172, v171, 16
    v_alignbit_b32 v135, v173, v172, 16
    ds_write_b128 v222, v[132:135] offset:15552
    v_readfirstlane_b32 s66, v13
    s_waitcnt lgkmcnt(0)
    s_barrier
    s_branch KF_CONV
KF_HP:
    v_lshrrev_b32 v2, 2, v1
    v_lshlrev_b32 v2, 10, v2
    v_and_b32 v3, 3, v1
    v_lshl_add_u32 v2, v3, 4, v2
    s_waitcnt lgkmcnt(0)
    s_mov_b32 s12, s4
    s_and_b32 s13, s5, 0xffff
    s_mov_b32 s16, s6
    s_and_b32 s17, s7, 0xffff
    s_mov_b32 s20, s10
    s_and_b32 s21, s11, 0xffff
    s_mov_b32 s60, s8
    s_and_b32 s61, s9, 0xffff
    s_sub_u32 s50, s24, 6
    s_lshl_b32 s52, s3, 1
    s_add_u32 s52, s52, s50
    s_cmp_lg_u32 s52, 0
    s_cbranch_scc1 KF_NOEP
    s_memrealtime s[68:69]
    v_mov_b32 v16, 0
    s_waitcnt lgkmcnt(0)
    s_or_b32 s68, s68, 1
    v_mov_b32 v17, s68
    s_mov_b64 exec, 1
    buffer_store_dword v17, v16, s[60:63], 0 offen sc0 sc1
    s_mov_b64 exec, -1
KF_NOEP:
    s_lshl_b32 s28, s26, 1
    s_add_u32 s28, s28, s50
    s_lshl_b32 s27, s25, 16
    s_lshl_b32 s32, s28, 6
    s_add_u32 s27, s27, s32
    s_mul_i32 s71, s50, 6144
    s_add_u32 s71, s71, 149504
    s_mov_b32 m0, s71
    s_add_u32 s32, s27, 15360
    s_add_u32 s33, s27, 30720
    s_add_u32 s34, s27, 46080
    buffer_load_dwordx4 v2, s[12:15], s27 offen lds
    buffer_load_dwordx4 v2, s[12:15], s32 offen offset:1024 lds
    buffer_load_dwordx4 v2, s[12:15], s33 offen offset:2048 lds
    buffer_load_dwordx4 v2, s[12:15], s34 offen offset:3072 lds
    s_lshl_b32 s38, s52, 1
    v_mov_b32 v3, s38
    global_load_ushort v110, v3, s[54:55]
    s_lshl_b32 s32, s28, 17
    s_lshl_b32 s33, s25, 7
    s_add_u32 s32, s32, s33
    s_add_u32 s32, s32, 8388608
    s_lshr_b32 s33, s3, 4
    s_lshl_b32 s33, s33, 12
    s_add_u32 s33, s33, 17891328
    s_sub_u32 s33, s33, s32
    v_and_b32 v9, 31, v1
    v_lshlrev_b32 v10, 12, v9
    v_lshlrev_b32 v9, 2, v9
    v_add_u32 v9, s33, v9
    v_cmp_gt_u32 vcc, 32, v1
    buffer_load_dword v225, v9, s[20:23], s32 offen sc1
    s_barrier
    v_lshrrev_b32 v9, 4, v1
    v_lshlrev_b32 v10, 9, v9
    v_bfe_u32 v11, v1, 2, 2
    v_lshl_add_u32 v10, v11, 6, v10
    v_and_b32 v11, 3, v1
    v_lshl_add_u32 v10, v11, 3, v10
    v_add_u32 v10, s71, v10
    v_and_b32 v11, 15, v1
    v_lshlrev_b32 v11, 12, v11
    v_lshl_add_u32 v11, v9, 4, v11
    s_lshl_b32 s32, s28, 17
    s_lshl_b32 s33, s25, 7
    s_add_u32 s32, s32, s33
    s_add_u32 s32, s32, 8388608
    s_add_u32 s33, s32, 65536
    s_lshl_b32 s68, s28, 12
    s_lshl_b32 s34, s25, 2
    s_add_u32 s68, s68, s34
    s_add_u32 s68, s68, 17891328
    s_lshr_b32 s69, s3, 4
    s_lshl_b32 s69, s69, 12
    s_add_u32 s69, s69, 17891328
    s_mul_i32 s28, s50, 30720
    v_and_b32 v12, 31, v1
    v_lshrrev_b32 v13, 5, v1
    v_mul_u32_u24 v3, 528, v12
    v_lshl_add_u32 v3, v13, 4, v3
    v_add_u32 v3, s28, v3
    v_mov_b32 v108, 0
    v_mov_b32 v134, v3
    v_mov_b32 v132, v10
    v_mov_b32 v231, v11
    s_mov_b32 s56, s32
    s_mov_b32 s57, s33
    s_and_b32 s33, s24, 1
    s_bfe_u32 s34, s24, 0x10001
    v_and_b32 v8, 15, v1
    v_lshrrev_b32 v9, 4, v1
    v_lshlrev_b32 v10, 3, v9
    v_sub_u32 v10, v10, v8
    v_add_u32 v10, 2031, v10
    v_and_b32 v11, 3, v10
    v_and_b32 v10, -4, v10
    v_lshlrev_b32 v10, 1, v10
    v_mul_u32_u24 v11, 4160, v11
    v_add_u32 v10, v10, v11
    s_mul_i32 s64, s33, 32768
    s_add_u32 s64, s64, 12288
    v_lshlrev_b32 v222, 4, v1
    v_add_u32 v222, s64, v222
    s_lshl_b32 s70, s34, 8
    s_sub_u32 s64, s64, s70
    s_sub_u32 s64, s64, 3776
    v_add_u32 v218, s64, v10
    v_lshl_add_u32 v220, v8, 1, v9
    v_lshlrev_b32 v220, 4, v220
    s_mul_i32 s64, s33, 6144
    s_add_u32 s64, s64, 149792
    s_sub_u32 s64, s64, s70
    v_add_u32 v220, s64, v220
    s_mul_i32 s64, s24, 4224
    s_add_u32 s64, s64, 65536
    v_lshlrev_b32 v221, 4, v1
    v_add_u32 v221, s64, v221
    s_xor_b32 s64, s24, 2
    s_mul_i32 s64, s64, 4224
    s_add_u32 s64, s64, 65536
    v_lshlrev_b32 v216, 4, v1
    v_add_u32 v216, s64, v216
    s_lshl_b32 s70, s3, 1
    s_add_u32 s70, s70, s33
    s_lshl_b32 s70, s70, 12
    s_lshl_b32 s64, s34, 11
    s_add_u32 s70, s70, s64
    s_add_u32 s70, s70, 15728640
    v_lshlrev_b32 v217, 5, v8
    v_lshl_add_u32 v217, v9, 3, v217
    s_lshl_b32 s64, s24, 2
    s_add_u32 s64, s64, 162832
    v_mov_b32 v223, s64
    v_or_b32 v230, 8, v223
    s_mul_i32 s64, s33, 32768
    v_sub_u32 v137, 63, v1
    v_lshlrev_b32 v137, 2, v137
    v_add_u32 v137, s64, v137
    v_and_b32 v138, 1, v1
    v_xor_b32 v138, 1, v138
    v_lshl_add_u32 v138, v138, 2, v137
    s_load_dwordx2 s[40:41], s[0:1], 16
    s_load_dwordx2 s[42:43], s[0:1], 104
    s_lshl_b32 s44, s25, 10
    s_lshl_b32 s45, s26, 5
    s_add_u32 s44, s44, s45
    s_add_u32 s44, s44, 18055168
    s_lshl_b32 s45, s3, 5
    s_add_u32 s45, s45, 18022400
    s_and_b32 s25, s2, 7
    s_lshl_b32 s25, s25, 2
    s_bfe_u32 s26, s2, 0x20003
    s_add_u32 s25, s25, s26
    s_lshr_b32 s26, s2, 5
    s_lshl_b32 s27, s25, 16
    s_and_b32 s36, s24, 3
    s_lshr_b32 s37, s24, 2
    s_lshl_b32 s28, s26, 3
    s_lshl_b32 s29, s36, 1
    s_add_u32 s28, s28, s29
    v_lshlrev_b32 v7, 4, v1
    s_lshl_b32 s30, s37, 5
    s_add_u32 s30, s30, s36
    s_mul_i32 s38, s30, 1056
    s_add_u32 s38, s38, 65536
    s_lshl_b32 s30, s30, 10
    s_add_u32 s31, s27, s30
    s_add_u32 s32, s31, 4194304
    s_add_u32 s31, s31, 2097152
    s_mov_b32 s46, 0
    v_and_b32 v177, 31, v1
    v_lshrrev_b32 v178, 5, v1
    s_lshl_b32 s53, s37, 15
    v_add_u32 v2, s53, v7
    s_mul_i32 s53, s37, 33792
    s_add_u32 s53, s53, 65536
    v_lshlrev_b32 v179, 8, v178
    v_and_b32 v182, 15, v1
    v_lshl_add_u32 v179, v182, 4, v179
    v_and_b32 v182, 27, v1
    v_cmp_eq_u32 vcc, 16, v182
    v_mov_b32 v182, 1040
    v_mov_b32 v183, 1024
    v_cndmask_b32 v182, v182, v183, vcc
    v_cmp_gt_u32 vcc, 16, v177
    v_subrev_u32 v183, 512, v182
    v_lshrrev_b32 v5, 3, v1
    v_cndmask_b32 v3, v182, v179, vcc
    v_cndmask_b32 v4, v183, v179, vcc
    v_add_u32 v3, s53, v3
    v_add_u32 v4, s53, v4
    v_bfe_u32 v182, v1, 4, 1
    v_lshlrev_b32 v182, 2, v182
    v_xor_b32 v182, v182, v1
    v_and_b32 v182, 7, v182
    v_lshlrev_b32 v6, 12, v5
    v_lshlrev_b32 v5, 10, v5
    v_lshl_add_u32 v5, v182, 4, v5
    v_lshl_add_u32 v6, v182, 4, v6
    s_lshl_b32 s53, s26, 10
    s_add_u32 s53, s53, 18022400
    s_lshl_b32 s54, s25, 10
    s_add_u32 s54, s54, 18055168
    v_lshlrev_b32 v182, 5, v177
    v_add_u32 v182, s53, v182
    v_and_b32 v183, 7, v1
    v_lshlrev_b32 v183, 5, v183
    v_add_u32 v183, s54, v183
    v_cmp_gt_u32 vcc, 32, v1
    v_lshlrev_b32 v229, 2, v1
    v_lshlrev_b32 v241, 2, v1
    v_add_u32 v245, 2097152, v7
    v_and_b32 v246, 0x7c, v229
    v_lshlrev_b32 v242, 2, v1
    s_lshl_b32 s47, s24, 10
    v_cndmask_b32 v227, v183, v182, vcc
    s_lshl_b32 s48, s24, 13
    s_lshl_b32 s49, s26, 7
    s_add_u32 s48, s48, s49
    s_mov_b32 s49, 0
    s_and_b32 s53, s24, 1
    v_lshrrev_b32 v176, 4, v1
    v_bfe_u32 v177, v1, 2, 2
    v_lshrrev_b32 v178, 1, v176
    v_lshlrev_b32 v178, 4, v178
    v_and_b32 v179, 1, v176
    v_lshl_add_u32 v178, v179, 2, v178
    v_add_u32 v178, v178, v177
    v_lshlrev_b32 v178, 7, v178
    v_lshrrev_b32 v179, 1, v177
    v_lshlrev_b32 v179, 6, v179
    v_and_b32 v180, 3, v1
    v_lshlrev_b32 v180, 3, v180
    s_lshr_b32 s54, s24, 1
    s_lshl_b32 s54, s54, 5
    v_add_u32 v232, s54, v180
    v_xor_b32 v232, v232, v179
    v_add_u32 v232, v232, v178
    v_lshl_add_u32 v233, v176, 2, v177
    v_lshlrev_b32 v233, 7, v233
    s_lshl_b32 s54, s53, 6
    v_add_u32 v181, s54, v180
    v_xor_b32 v181, v181, v179
    v_add_u32 v233, v233, v181
    s_lshr_b32 s54, s24, 1
    s_lshl_b32 s54, s54, 11
    s_add_u32 s54, s54, 133120
    v_add_u32 v233, s54, v233
    v_lshlrev_b32 v234, 9, v176
    v_and_b32 v181, 15, v1
    v_lshl_add_u32 v234, v181, 4, v234
    s_lshl_b32 s54, s53, 12
    v_add_u32 v234, s54, v234
    v_add_u32 v235, 82432, v234
    v_lshlrev_b32 v236, 10, v181
    v_lshl_add_u32 v236, v176, 3, v236
    s_mul_i32 s53, s24, 2176
    s_add_u32 s53, s53, 145408
    s_xor_b32 s54, s24, 4
    s_mul_i32 s54, s54, 2176
    s_add_u32 s54, s54, 145408
    v_add_u32 v237, s53, v7
    v_add_u32 v238, s54, v7
    v_and_b32 v239, 0x7c, v229
    v_add_u32 v240, s54, v239
    v_add_u32 v239, s53, v239
    s_waitcnt lgkmcnt(0)
    s_mov_b32 s4, s40
    s_and_b32 s5, s41, 0xffff
    s_mov_b32 s6, 0x80000
    s_mov_b32 s7, 0x00020000
    s_mov_b32 s8, s42
    s_and_b32 s9, s43, 0xffff
    s_mov_b32 s10, 0x200000
    s_mov_b32 s11, 0x00020000
    s_add_u32 s30, s30, 4096
    s_add_u32 s31, s31, 4096
    s_add_u32 s32, s32, 4096
    s_add_u32 s38, s38, 4224
    s_waitcnt vmcnt(2)
    ds_read_b64_tr_b16 v[192:193], v132 offset:0
    ds_read_b64_tr_b16 v[194:195], v132 offset:256
    ds_read_b64_tr_b16 v[196:197], v132 offset:2048
    ds_read_b64_tr_b16 v[198:199], v132 offset:2304
    ds_read_b64_tr_b16 v[200:201], v132 offset:32
    ds_read_b64_tr_b16 v[202:203], v132 offset:288
    ds_read_b64_tr_b16 v[204:205], v132 offset:2080
    ds_read_b64_tr_b16 v[206:207], v132 offset:2336
    s_waitcnt lgkmcnt(0)
    buffer_store_dwordx4 v[192:195], v231, s[20:23], s56 offen offset:0
    buffer_store_dwordx4 v[196:199], v231, s[20:23], s56 offen offset:64
    buffer_store_dwordx4 v[200:203], v231, s[20:23], s57 offen offset:0
    buffer_store_dwordx4 v[204:207], v231, s[20:23], s57 offen offset:64
    buffer_load_dword v109, v108, s[60:63], 0 offen sc0 sc1
    s_barrier
    ds_read_b128 v[20:23], v134 offset:0
    ds_read_b128 v[24:27], v134 offset:13200
    ds_read_b128 v[28:31], v134 offset:32
    ds_read_b128 v[32:35], v134 offset:13232
    ds_read_b128 v[36:39], v134 offset:64
    ds_read_b128 v[40:43], v134 offset:13264
    ds_read_b128 v[44:47], v134 offset:96
    ds_read_b128 v[48:51], v134 offset:13296
    ds_read_b128 v[52:55], v134 offset:128
    ds_read_b128 v[56:59], v134 offset:13328
    ds_read_b128 v[60:63], v134 offset:160
    ds_read_b128 v[64:67], v134 offset:13360
    s_waitcnt lgkmcnt(10)
    v_mfma_f32_32x32x16_bf16 v[140:155], v[20:23], v[24:27], 0
    ds_read_b128 v[68:71], v134 offset:192
    ds_read_b128 v[72:75], v134 offset:13392
    s_waitcnt lgkmcnt(10)
    v_mfma_f32_32x32x16_bf16 v[140:155], v[28:31], v[32:35], v[140:155]
    ds_read_b128 v[76:79], v134 offset:224
    ds_read_b128 v[80:83], v134 offset:13424
    s_barrier
    s_waitcnt vmcnt(0)
    v_readfirstlane_b32 s66, v109
    s_nop 0
    s_cmp_lg_u32 s66, 0
    s_cbranch_scc1 KF_EPOK
    v_mov_b32 v108, 0
    s_mov_b32 s67, 400000
EP1:
    buffer_load_dword v109, v108, s[60:63], 0 offen sc0 sc1
    s_sub_u32 s67, s67, 1
    s_waitcnt vmcnt(0)
    v_readfirstlane_b32 s66, v109
    s_cmp_eq_u32 s67, 0
    s_cbranch_scc1 EP1_X
    s_cmp_eq_u32 s66, 0
    s_cbranch_scc1 EP1
EP1_X:
KF_EPOK:
    s_getreg_b32 s59, hwreg(HW_REG_XCC_ID, 0, 4)
    s_lshl_b32 s59, s59, 1
    s_add_u32 s59, s59, 2
    s_add_u32 s59, s59, s66
    v_mov_b32 v108, 0
    v_mov_b32 v109, s66
    v_mov_b32 v107, s59
    s_mov_b64 exec, 1
    buffer_store_dword v107, v108, s[20:23], s68 offen
    s_mov_b64 exec, -1
    s_waitcnt lgkmcnt(10)
    v_mfma_f32_32x32x16_bf16 v[140:155], v[36:39], v[40:43], v[140:155]
    ds_read_b128 v[20:23], v134 offset:256
    ds_read_b128 v[24:27], v134 offset:13456
    s_waitcnt lgkmcnt(10)
    v_mfma_f32_32x32x16_bf16 v[140:155], v[44:47], v[48:51], v[140:155]
    ds_read_b128 v[28:31], v134 offset:288
    ds_read_b128 v[32:35], v134 offset:13488
    s_barrier
    s_waitcnt lgkmcnt(10)
    v_mfma_f32_32x32x16_bf16 v[140:155], v[52:55], v[56:59], v[140:155]
    ds_read_b128 v[36:39], v134 offset:320
    ds_read_b128 v[40:43], v134 offset:13520
    s_waitcnt lgkmcnt(10)
    v_mfma_f32_32x32x16_bf16 v[140:155], v[60:63], v[64:67], v[140:155]
    ds_read_b128 v[44:47], v134 offset:352
    ds_read_b128 v[48:51], v134 offset:13552
    s_barrier
    s_waitcnt lgkmcnt(10)
    v_mfma_f32_32x32x16_bf16 v[140:155], v[68:71], v[72:75], v[140:155]
    ds_read_b128 v[52:55], v134 offset:384
    ds_read_b128 v[56:59], v134 offset:13584
    s_waitcnt lgkmcnt(10)
    v_mfma_f32_32x32x16_bf16 v[140:155], v[76:79], v[80:83], v[140:155]
    ds_read_b128 v[60:63], v134 offset:416
    ds_read_b128 v[64:67], v134 offset:13616
    s_barrier
    s_waitcnt lgkmcnt(10)
    v_mfma_f32_32x32x16_bf16 v[140:155], v[20:23], v[24:27], v[140:155]
    ds_read_b128 v[68:71], v134 offset:448
    ds_read_b128 v[72:75], v134 offset:13648
    s_waitcnt lgkmcnt(10)
    v_mfma_f32_32x32x16_bf16 v[140:155], v[28:31], v[32:35], v[140:155]
    ds_read_b128 v[76:79], v134 offset:480
    ds_read_b128 v[80:83], v134 offset:13680
    s_barrier
    s_waitcnt lgkmcnt(10)
    v_mfma_f32_32x32x16_bf16 v[140:155], v[36:39], v[40:43], v[140:155]
    s_waitcnt lgkmcnt(8)
    v_mfma_f32_32x32x16_bf16 v[140:155], v[44:47], v[48:51], v[140:155]
    s_barrier
    s_waitcnt lgkmcnt(6)
    v_mfma_f32_32x32x16_bf16 v[140:155], v[52:55], v[56:59], v[140:155]
    s_waitcnt lgkmcnt(4)
    v_mfma_f32_32x32x16_bf16 v[140:155], v[60:63], v[64:67], v[140:155]
    s_barrier
    s_waitcnt lgkmcnt(2)
    v_mfma_f32_32x32x16_bf16 v[140:155], v[68:71], v[72:75], v[140:155]
    s_waitcnt lgkmcnt(0)
    v_mfma_f32_32x32x16_bf16 v[140:155], v[76:79], v[80:83], v[140:155]
    s_barrier
    v_lshlrev_b32 v104, 2, v12
    v_mov_b32 v158, v104
    buffer_load_dword v105, v104, s[20:23], s69 offen sc1
    s_barrier
    s_barrier
    s_mul_i32 s33, s50, 32768
    s_add_u32 s33, s33, 0
    s_mul_i32 s34, s50, 32768
    s_add_u32 s34, s34, 12288
    v_lshlrev_b32 v11, 16, v110
    v_cmp_eq_u32 vcc, 0, v1
    v_mul_u32_u24 v136, 1184, v13
    v_add_u32 v136, v136, v12
    v_cndmask_b32 v11, 0, v11, vcc
    v_lshlrev_b32 v136, 2, v136
    v_add_u32 v136, s33, v136
    v_add_f32 v140, v140, v11
    v_mov_b32 v106, 162816
    v_mov_b32 v110, 0
    v_mov_b32 v111, 0
    v_lshrrev_b32 v139, 4, v1
    v_mul_u32_u24 v139, 4160, v139
    v_and_b32 v135, 15, v1
    v_lshl_add_u32 v139, v135, 2, v139
    v_add_u32 v139, s34, v139
    s_barrier
    s_barrier
    s_waitcnt vmcnt(0)
    v_cmp_ne_u32 vcc, s59, v105
    v_mov_b32 v112, 0
    s_cmp_eq_u64 vcc, 0
    s_cselect_b32 s65, 1, 0
    v_mov_b32 v113, s65
    s_cmp_eq_u32 s65, 0
    s_cbranch_scc1 KF_ULATE0
    s_lshl_b32 s34, s52, 12
    s_add_u32 s34, s34, 8388608
    v_lshlrev_b32 v14, 4, v1
    s_add_u32 m0, s71, 512
    s_nop 0
    buffer_load_dwordx4 v14, s[20:23], s34 offen offset:0 sc1 lds
    buffer_load_dwordx4 v14, s[20:23], s34 offen offset:1024 sc1 lds
    buffer_load_dwordx4 v14, s[20:23], s34 offen offset:2048 sc1 lds
    buffer_load_dwordx4 v14, s[20:23], s34 offen offset:3072 sc1 lds
KF_ULATE0:
    v_mov_b32 v56, 0
    v_mov_b32 v57, 0
    v_mov_b32 v58, 0
    v_mov_b32 v59, 0
    v_mov_b32 v60, 0
    v_mov_b32 v61, 0
    v_mov_b32 v62, 0
    v_mov_b32 v63, 0
    v_mov_b32 v64, 0
    v_mov_b32 v65, 0
    v_mov_b32 v66, 0
    v_mov_b32 v67, 0
    v_mov_b32 v68, 0
    v_mov_b32 v69, 0
    v_mov_b32 v70, 0
    v_mov_b32 v71, 0
    v_mov_b32 v72, 0
    v_mov_b32 v73, 0
    v_mov_b32 v74, 0
    v_mov_b32 v75, 0
    v_mov_b32 v76, 0
    v_mov_b32 v77, 0
    v_mov_b32 v78, 0
    v_mov_b32 v79, 0
    v_mov_b32 v80, 0
    v_mov_b32 v81, 0
    v_mov_b32 v82, 0
    v_mov_b32 v83, 0
    v_mov_b32 v84, 0
    v_mov_b32 v85, 0
    v_mov_b32 v86, 0
    v_mov_b32 v87, 0
    v_mov_b32 v52, 0
    v_mov_b32 v53, 0
    v_mov_b32 v54, 0
    v_mov_b32 v55, 0
    s_barrier
    s_cmp_eq_u32 s65, 1
    s_cbranch_scc1 KF_NR1
    buffer_load_dword v105, v104, s[20:23], s69 offen sc1
KF_NR1:
    ds_write_b32 v136, v140 offset:4
    ds_write_b32 v136, v141 offset:1188
    ds_write_b32 v136, v142 offset:2372
    ds_write_b32 v136, v143 offset:3556
    ds_write_b32 v136, v144 offset:132
    ds_write_b32 v136, v145 offset:2500
    ds_write_b32 v136, v146 offset:260
    s_barrier
    ds_write_b32 v136, v147 offset:388
    ds_write_b32 v136, v148 offset:516
    ds_write_b32 v136, v149 offset:644
    ds_write_b32 v136, v150 offset:772
    ds_write_b32 v136, v151 offset:900
    ds_write_b32 v136, v152 offset:1028
    s_cmp_eq_u32 s65, 1
    s_cbranch_scc1 KF_ULATE1
    s_mov_b32 s67, 12
KF_RT:
    s_waitcnt vmcnt(0)
    v_cmp_ne_u32 vcc, s59, v105
    s_sub_u32 s67, s67, 1
    s_cmp_eq_u32 s67, 0
    s_cbranch_scc1 KF_RTX
    s_cbranch_vccz KF_RTX
    s_sleep 4
    buffer_load_dword v105, v104, s[20:23], s69 offen sc1
    s_branch KF_RT
KF_RTX:
    s_waitcnt vmcnt(0)
    v_cmp_ne_u32 vcc, s59, v105
    v_mov_b32 v112, 0
    s_cmp_eq_u64 vcc, 0
    s_cselect_b32 s65, 1, 0
    v_mov_b32 v113, s65
    s_cmp_eq_u32 s65, 0
    s_cbranch_scc1 KF_ULATE1
    s_lshl_b32 s34, s52, 12
    s_add_u32 s34, s34, 8388608
    v_lshlrev_b32 v14, 4, v1
    s_add_u32 m0, s71, 512
    s_nop 0
    buffer_load_dwordx4 v14, s[20:23], s34 offen offset:0 sc1 lds
    buffer_load_dwordx4 v14, s[20:23], s34 offen offset:1024 sc1 lds
    buffer_load_dwordx4 v14, s[20:23], s34 offen offset:2048 sc1 lds
    buffer_load_dwordx4 v14, s[20:23], s34 offen offset:3072 sc1 lds
KF_ULATE1:
    s_cmp_lg_u32 s50, 0
    s_cbranch_scc1 KF_NOLW
    s_mov_b64 exec, 1
    ds_write_b64 v106, v[108:109]
    ds_write_b64 v106, v[112:113] offset:16
    s_mov_b64 exec, -1
KF_NOLW:
    ds_write_b32 v139, v108 offset:4096
    s_waitcnt lgkmcnt(0)
    s_barrier
    ds_read_b32 v20, v137 offset:776
    ds_read_b32 v21, v137 offset:772
    ds_read_b32 v22, v138 offset:772
    ds_read_b32 v23, v137 offset:520
    ds_read_b32 v24, v137 offset:516
    ds_read_b32 v25, v138 offset:516
    ds_read_b32 v26, v137 offset:264
    ds_read_b32 v27, v137 offset:4996
    ds_read_b32 v28, v137 offset:260
    s_waitcnt lgkmcnt(0)
    v_cvt_pk_bf16_f32 v160, v20, v20
    v_cvt_pk_bf16_f32 v161, v20, v22
    v_cvt_pk_bf16_f32 v162, v21, v21
    v_cvt_pk_bf16_f32 v163, v21, v21
    ds_write_b128 v222, v[160:163] offset:0
    v_cvt_pk_bf16_f32 v168, v23, v23
    v_cvt_pk_bf16_f32 v169, v23, v25
    v_cvt_pk_bf16_f32 v170, v24, v24
    v_cvt_pk_bf16_f32 v171, v24, v24
    ds_write_b128 v222, v[168:171] offset:1024
    v_cvt_pk_bf16_f32 v176, v26, v26
    v_cvt_pk_bf16_f32 v177, v27, v27
    v_cvt_pk_bf16_f32 v178, v27, v28
    v_cvt_pk_bf16_f32 v179, v28, v28
    ds_write_b128 v222, v[176:179] offset:2048
    ds_read_b64 v[164:165], v222 offset:16
    ds_read_b64 v[172:173], v222 offset:1040
    s_waitcnt lgkmcnt(1)
    v_alignbit_b32 v112, v161, v160, 16
    v_alignbit_b32 v113, v162, v161, 16
    v_alignbit_b32 v114, v163, v162, 16
    v_alignbit_b32 v115, v164, v163, 16
    ds_write_b128 v222, v[112:115] offset:4160
    v_mov_b32 v116, v161
    v_mov_b32 v117, v162
    v_mov_b32 v118, v163
    v_mov_b32 v119, v164
    ds_write_b128 v222, v[116:119] offset:8320
    v_alignbit_b32 v120, v162, v161, 16
    v_alignbit_b32 v121, v163, v162, 16
    v_alignbit_b32 v122, v164, v163, 16
    v_alignbit_b32 v123, v165, v164, 16
    ds_write_b128 v222, v[120:123] offset:12480
    s_waitcnt lgkmcnt(3)
    v_alignbit_b32 v124, v169, v168, 16
    v_alignbit_b32 v125, v170, v169, 16
    v_alignbit_b32 v126, v171, v170, 16
    v_alignbit_b32 v127, v172, v171, 16
    ds_write_b128 v222, v[124:127] offset:5184
    v_mov_b32 v128, v169
    v_mov_b32 v129, v170
    v_mov_b32 v130, v171
    v_mov_b32 v131, v172
    ds_write_b128 v222, v[128:131] offset:9344
    v_alignbit_b32 v132, v170, v169, 16
    v_alignbit_b32 v133, v171, v170, 16
    v_alignbit_b32 v134, v172, v171, 16
    v_alignbit_b32 v135, v173, v172, 16
    ds_write_b128 v222, v[132:135] offset:13504
    s_cmp_eq_u32 s65, 1
    s_cbranch_scc0 KF_UL2
    s_waitcnt vmcnt(0)
    s_mov_b64 exec, 1
    ds_write_b32 v223, v109
    s_mov_b64 exec, -1
    s_waitcnt lgkmcnt(0)
    s_barrier
    s_branch KF_UL3
KF_UL2:
    s_waitcnt lgkmcnt(0)
    s_barrier
    buffer_store_dwordx4 v[192:195], v231, s[20:23], s56 offen offset:0 sc1
    buffer_store_dwordx4 v[196:199], v231, s[20:23], s56 offen offset:64 sc1
    buffer_store_dwordx4 v[200:203], v231, s[20:23], s57 offen offset:0 sc1
    buffer_store_dwordx4 v[204:207], v231, s[20:23], s57 offen offset:64 sc1
    s_add_u32 s33, s68, 65536
    s_add_u32 s58, s69, 65536
    s_waitcnt vmcnt(0)
    s_mov_b64 exec, 1
    buffer_store_dword v109, v108, s[20:23], s33 offen sc0 sc1
    s_mov_b64 exec, -1
    s_mov_b32 s67, 400000
KF_UP:
    buffer_load_dword v159, v158, s[20:23], s69 offen sc1
    buffer_load_dword v157, v158, s[20:23], s58 offen sc1
    s_sub_u32 s67, s67, 1
    s_waitcnt vmcnt(0)
    v_cmp_ne_u32 vcc, s59, v159
    s_cmp_eq_u32 s67, 0
    s_cbranch_scc1 KF_UPX
    s_cbranch_vccz KF_UPX
    v_cmp_ne_u32 vcc, s66, v157
    s_nop 1
    s_cbranch_vccz KF_UPX
    s_sleep 2
    s_branch KF_UP
KF_UPX:
    s_lshl_b32 s34, s52, 12
    s_add_u32 s34, s34, 8388608
    v_lshlrev_b32 v14, 4, v1
    s_add_u32 m0, s71, 512
    s_nop 0
    buffer_load_dwordx4 v14, s[20:23], s34 offen offset:0 sc1 lds
    buffer_load_dwordx4 v14, s[20:23], s34 offen offset:1024 sc1 lds
    buffer_load_dwordx4 v14, s[20:23], s34 offen offset:2048 sc1 lds
    buffer_load_dwordx4 v14, s[20:23], s34 offen offset:3072 sc1 lds
    s_waitcnt vmcnt(0)
    s_mov_b64 exec, 1
    ds_write_b32 v223, v109
    s_mov_b64 exec, -1
    s_waitcnt lgkmcnt(0)
KF_UL3:
    v_mov_b32 v109, 0
KF_CONV:
KF_CW:
    ds_read_b32 v14, v230
    ds_read_b64 v[16:17], v218 offset:3776
    ds_read_b64 v[18:19], v218 offset:3784
    ds_read_b128 v[112:115], v220 offset:192
    ds_read_b128 v[116:119], v220 offset:704
    ds_read_b128 v[120:123], v220 offset:1216
    ds_read_b128 v[124:127], v220 offset:1728
    ds_read_b128 v[128:131], v220 offset:2240
    ds_read_b128 v[132:135], v220 offset:2752
    ds_read_b128 v[136:139], v220 offset:3264
    ds_read_b128 v[140:143], v220 offset:3776
    ds_read_b64 v[20:21], v218 offset:3264
    ds_read_b64 v[22:23], v218 offset:3272
    s_waitcnt lgkmcnt(12)
    v_readfirstlane_b32 s33, v14
    s_nop 0
    s_cmp_eq_u32 s33, s66
    s_cbranch_scc0 KF_CW
    s_waitcnt lgkmcnt(9)
    v_mfma_f32_16x16x32_bf16 v[184:187], v[16:19], v[112:115], 0
    ds_read_b64 v[24:25], v218 offset:2752
    s_waitcnt lgkmcnt(9)
    v_mfma_f32_16x16x32_bf16 v[188:191], v[16:19], v[116:119], 0
    ds_read_b64 v[26:27], v218 offset:2760
    s_waitcnt lgkmcnt(9)
    v_mfma_f32_16x16x32_bf16 v[192:195], v[16:19], v[120:123], 0
    ds_read_b64 v[28:29], v218 offset:2240
    s_waitcnt lgkmcnt(9)
    v_mfma_f32_16x16x32_bf16 v[196:199], v[16:19], v[124:127], 0
    ds_read_b64 v[30:31], v218 offset:2248
    s_waitcnt lgkmcnt(9)
    v_mfma_f32_16x16x32_bf16 v[200:203], v[16:19], v[128:131], 0
    ds_read_b64 v[32:33], v218 offset:1728
    s_waitcnt lgkmcnt(9)
    v_mfma_f32_16x16x32_bf16 v[204:207], v[16:19], v[132:135], 0
    ds_read_b64 v[34:35], v218 offset:1736
    s_waitcnt lgkmcnt(9)
    v_mfma_f32_16x16x32_bf16 v[208:211], v[16:19], v[136:139], 0
    ds_read_b64 v[36:37], v218 offset:1216
    s_waitcnt lgkmcnt(9)
    v_mfma_f32_16x16x32_bf16 v[212:215], v[16:19], v[140:143], 0
    ds_read_b64 v[38:39], v218 offset:1224
    s_waitcnt lgkmcnt(4)
    v_mfma_f32_16x16x32_bf16 v[188:191], v[20:23], v[112:115], v[188:191]
    ds_read_b64 v[40:41], v218 offset:704
    v_mfma_f32_16x16x32_bf16 v[192:195], v[20:23], v[116:119], v[192:195]
    ds_read_b64 v[42:43], v218 offset:712
    v_mfma_f32_16x16x32_bf16 v[196:199], v[20:23], v[120:123], v[196:199]
    ds_read_b64 v[44:45], v218 offset:192
    v_mfma_f32_16x16x32_bf16 v[200:203], v[20:23], v[124:127], v[200:203]
    ds_read_b64 v[46:47], v218 offset:200
    v_mfma_f32_16x16x32_bf16 v[204:207], v[20:23], v[128:131], v[204:207]
    ds_read_b128 v[144:147], v220 offset:128
    v_mfma_f32_16x16x32_bf16 v[208:211], v[20:23], v[132:135], v[208:211]
    ds_read_b128 v[148:151], v220 offset:640
    v_mfma_f32_16x16x32_bf16 v[212:215], v[20:23], v[136:139], v[212:215]
    ds_read_b128 v[152:155], v220 offset:1152
    v_mfma_f32_16x16x32_bf16 v[192:195], v[24:27], v[112:115], v[192:195]
    ds_read_b128 v[156:159], v220 offset:1664
    v_mfma_f32_16x16x32_bf16 v[196:199], v[24:27], v[116:119], v[196:199]
    ds_read_b128 v[160:163], v220 offset:2176
    v_mfma_f32_16x16x32_bf16 v[200:203], v[24:27], v[120:123], v[200:203]
    ds_read_b128 v[164:167], v220 offset:2688
    v_mfma_f32_16x16x32_bf16 v[204:207], v[24:27], v[124:127], v[204:207]
    ds_read_b128 v[168:171], v220 offset:3200
    v_mfma_f32_16x16x32_bf16 v[208:211], v[24:27], v[128:131], v[208:211]
    ds_read_b128 v[172:175], v220 offset:3712
    v_mfma_f32_16x16x32_bf16 v[212:215], v[24:27], v[132:135], v[212:215]
    ds_read_b64 v[16:17], v218 offset:3712
    v_mfma_f32_16x16x32_bf16 v[196:199], v[28:31], v[112:115], v[196:199]
    ds_read_b64 v[18:19], v218 offset:3720
    v_mfma_f32_16x16x32_bf16 v[200:203], v[28:31], v[116:119], v[200:203]
    ds_read_b64 v[20:21], v218 offset:3200
    v_mfma_f32_16x16x32_bf16 v[204:207], v[28:31], v[120:123], v[204:207]
    ds_read_b64 v[22:23], v218 offset:3208
    v_mfma_f32_16x16x32_bf16 v[208:211], v[28:31], v[124:127], v[208:211]
    ds_read_b64 v[24:25], v218 offset:2688
    v_mfma_f32_16x16x32_bf16 v[212:215], v[28:31], v[128:131], v[212:215]
    ds_read_b64 v[26:27], v218 offset:2696
    s_waitcnt lgkmcnt(4)
    v_mfma_f32_16x16x32_bf16 v[200:203], v[32:35], v[112:115], v[200:203]
    ds_read_b64 v[28:29], v218 offset:2176
    v_mfma_f32_16x16x32_bf16 v[204:207], v[32:35], v[116:119], v[204:207]
    ds_read_b64 v[30:31], v218 offset:2184
    v_mfma_f32_16x16x32_bf16 v[208:211], v[32:35], v[120:123], v[208:211]
    v_mfma_f32_16x16x32_bf16 v[212:215], v[32:35], v[124:127], v[212:215]
    ds_read_b64 v[32:33], v218 offset:1664
    v_mfma_f32_16x16x32_bf16 v[204:207], v[36:39], v[112:115], v[204:207]
    ds_read_b64 v[34:35], v218 offset:1672
    v_mfma_f32_16x16x32_bf16 v[208:211], v[36:39], v[116:119], v[208:211]
    v_mfma_f32_16x16x32_bf16 v[212:215], v[36:39], v[120:123], v[212:215]
    ds_read_b64 v[36:37], v218 offset:1152
    v_mfma_f32_16x16x32_bf16 v[208:211], v[40:43], v[112:115], v[208:211]
    ds_read_b64 v[38:39], v218 offset:1160
    v_mfma_f32_16x16x32_bf16 v[212:215], v[40:43], v[116:119], v[212:215]
    ds_read_b64 v[40:41], v218 offset:640
    v_mfma_f32_16x16x32_bf16 v[212:215], v[44:47], v[112:115], v[212:215]
    ds_read_b64 v[42:43], v218 offset:648
    v_mfma_f32_16x16x32_bf16 v[184:187], v[16:19], v[144:147], v[184:187]
    ds_read_b64 v[44:45], v218 offset:128
    v_mfma_f32_16x16x32_bf16 v[188:191], v[16:19], v[148:151], v[188:191]
    ds_read_b64 v[46:47], v218 offset:136
    v_mfma_f32_16x16x32_bf16 v[192:195], v[16:19], v[152:155], v[192:195]
    ds_read_b128 v[112:115], v220 offset:64
    v_mfma_f32_16x16x32_bf16 v[196:199], v[16:19], v[156:159], v[196:199]
    ds_read_b128 v[116:119], v220 offset:576
    v_mfma_f32_16x16x32_bf16 v[200:203], v[16:19], v[160:163], v[200:203]
    ds_read_b128 v[120:123], v220 offset:1088
    v_mfma_f32_16x16x32_bf16 v[204:207], v[16:19], v[164:167], v[204:207]
    ds_read_b128 v[124:127], v220 offset:1600
    v_mfma_f32_16x16x32_bf16 v[208:211], v[16:19], v[168:171], v[208:211]
    ds_read_b128 v[128:131], v220 offset:2112
    v_mfma_f32_16x16x32_bf16 v[212:215], v[16:19], v[172:175], v[212:215]
    ds_read_b128 v[132:135], v220 offset:2624
    s_waitcnt lgkmcnt(4)
    v_mfma_f32_16x16x32_bf16 v[188:191], v[20:23], v[144:147], v[188:191]
    ds_read_b128 v[136:139], v220 offset:3136
    v_mfma_f32_16x16x32_bf16 v[192:195], v[20:23], v[148:151], v[192:195]
    ds_read_b128 v[140:143], v220 offset:3648
    v_mfma_f32_16x16x32_bf16 v[196:199], v[20:23], v[152:155], v[196:199]
    ds_read_b64 v[16:17], v218 offset:3648
    v_mfma_f32_16x16x32_bf16 v[200:203], v[20:23], v[156:159], v[200:203]
    ds_read_b64 v[18:19], v218 offset:3656
    v_mfma_f32_16x16x32_bf16 v[204:207], v[20:23], v[160:163], v[204:207]
    v_mfma_f32_16x16x32_bf16 v[208:211], v[20:23], v[164:167], v[208:211]
    v_mfma_f32_16x16x32_bf16 v[212:215], v[20:23], v[168:171], v[212:215]
    ds_read_b64 v[20:21], v218 offset:3136
    v_mfma_f32_16x16x32_bf16 v[192:195], v[24:27], v[144:147], v[192:195]
    ds_read_b64 v[22:23], v218 offset:3144
    v_mfma_f32_16x16x32_bf16 v[196:199], v[24:27], v[148:151], v[196:199]
    v_mfma_f32_16x16x32_bf16 v[200:203], v[24:27], v[152:155], v[200:203]
    v_mfma_f32_16x16x32_bf16 v[204:207], v[24:27], v[156:159], v[204:207]
    v_mfma_f32_16x16x32_bf16 v[208:211], v[24:27], v[160:163], v[208:211]
    v_mfma_f32_16x16x32_bf16 v[212:215], v[24:27], v[164:167], v[212:215]
    ds_read_b64 v[24:25], v218 offset:2624
    v_mfma_f32_16x16x32_bf16 v[196:199], v[28:31], v[144:147], v[196:199]
    ds_read_b64 v[26:27], v218 offset:2632
    v_mfma_f32_16x16x32_bf16 v[200:203], v[28:31], v[148:151], v[200:203]
    v_mfma_f32_16x16x32_bf16 v[204:207], v[28:31], v[152:155], v[204:207]
    v_mfma_f32_16x16x32_bf16 v[208:211], v[28:31], v[156:159], v[208:211]
    v_mfma_f32_16x16x32_bf16 v[212:215], v[28:31], v[160:163], v[212:215]
    ds_read_b64 v[28:29], v218 offset:2112
    v_mfma_f32_16x16x32_bf16 v[200:203], v[32:35], v[144:147], v[200:203]
    ds_read_b64 v[30:31], v218 offset:2120
    v_mfma_f32_16x16x32_bf16 v[204:207], v[32:35], v[148:151], v[204:207]
    v_mfma_f32_16x16x32_bf16 v[208:211], v[32:35], v[152:155], v[208:211]
    v_mfma_f32_16x16x32_bf16 v[212:215], v[32:35], v[156:159], v[212:215]
    ds_read_b64 v[32:33], v218 offset:1600
    v_mfma_f32_16x16x32_bf16 v[204:207], v[36:39], v[144:147], v[204:207]
    ds_read_b64 v[34:35], v218 offset:1608
    v_mfma_f32_16x16x32_bf16 v[208:211], v[36:39], v[148:151], v[208:211]
    v_mfma_f32_16x16x32_bf16 v[212:215], v[36:39], v[152:155], v[212:215]
    ds_read_b64 v[36:37], v218 offset:1088
    v_mfma_f32_16x16x32_bf16 v[208:211], v[40:43], v[144:147], v[208:211]
    ds_read_b64 v[38:39], v218 offset:1096
    v_mfma_f32_16x16x32_bf16 v[212:215], v[40:43], v[148:151], v[212:215]
    ds_read_b64 v[40:41], v218 offset:576
    v_mfma_f32_16x16x32_bf16 v[212:215], v[44:47], v[144:147], v[212:215]
    ds_read_b64 v[42:43], v218 offset:584
    s_waitcnt lgkmcnt(4)
    v_mfma_f32_16x16x32_bf16 v[184:187], v[16:19], v[112:115], v[184:187]
    ds_read_b64 v[44:45], v218 offset:64
    v_mfma_f32_16x16x32_bf16 v[188:191], v[16:19], v[116:119], v[188:191]
    ds_read_b64 v[46:47], v218 offset:72
    v_mfma_f32_16x16x32_bf16 v[192:195], v[16:19], v[120:123], v[192:195]
    ds_read_b128 v[144:147], v220 offset:0
    v_mfma_f32_16x16x32_bf16 v[196:199], v[16:19], v[124:127], v[196:199]
    ds_read_b128 v[148:151], v220 offset:512
    v_mfma_f32_16x16x32_bf16 v[200:203], v[16:19], v[128:131], v[200:203]
    ds_read_b128 v[152:155], v220 offset:1024
    v_mfma_f32_16x16x32_bf16 v[204:207], v[16:19], v[132:135], v[204:207]
    ds_read_b128 v[156:159], v220 offset:1536
    v_mfma_f32_16x16x32_bf16 v[208:211], v[16:19], v[136:139], v[208:211]
    ds_read_b128 v[160:163], v220 offset:2048
    v_mfma_f32_16x16x32_bf16 v[212:215], v[16:19], v[140:143], v[212:215]
    ds_read_b128 v[164:167], v220 offset:2560
    v_mfma_f32_16x16x32_bf16 v[188:191], v[20:23], v[112:115], v[188:191]
    ds_read_b128 v[168:171], v220 offset:3072
    v_mfma_f32_16x16x32_bf16 v[192:195], v[20:23], v[116:119], v[192:195]
    ds_read_b128 v[172:175], v220 offset:3584
    v_mfma_f32_16x16x32_bf16 v[196:199], v[20:23], v[120:123], v[196:199]
    ds_read_b64 v[16:17], v218 offset:3584
    v_mfma_f32_16x16x32_bf16 v[200:203], v[20:23], v[124:127], v[200:203]
    ds_read_b64 v[18:19], v218 offset:3592
    v_mfma_f32_16x16x32_bf16 v[204:207], v[20:23], v[128:131], v[204:207]
    v_mfma_f32_16x16x32_bf16 v[208:211], v[20:23], v[132:135], v[208:211]
    v_mfma_f32_16x16x32_bf16 v[212:215], v[20:23], v[136:139], v[212:215]
    ds_read_b64 v[20:21], v218 offset:3072
    v_mfma_f32_16x16x32_bf16 v[192:195], v[24:27], v[112:115], v[192:195]
    ds_read_b64 v[22:23], v218 offset:3080
    v_mfma_f32_16x16x32_bf16 v[196:199], v[24:27], v[116:119], v[196:199]
    v_mfma_f32_16x16x32_bf16 v[200:203], v[24:27], v[120:123], v[200:203]
    v_mfma_f32_16x16x32_bf16 v[204:207], v[24:27], v[124:127], v[204:207]
    v_mfma_f32_16x16x32_bf16 v[208:211], v[24:27], v[128:131], v[208:211]
    v_mfma_f32_16x16x32_bf16 v[212:215], v[24:27], v[132:135], v[212:215]
    ds_read_b64 v[24:25], v218 offset:2560
    v_mfma_f32_16x16x32_bf16 v[196:199], v[28:31], v[112:115], v[196:199]
    ds_read_b64 v[26:27], v218 offset:2568
    v_mfma_f32_16x16x32_bf16 v[200:203], v[28:31], v[116:119], v[200:203]
    v_mfma_f32_16x16x32_bf16 v[204:207], v[28:31], v[120:123], v[204:207]
    v_mfma_f32_16x16x32_bf16 v[208:211], v[28:31], v[124:127], v[208:211]
    v_mfma_f32_16x16x32_bf16 v[212:215], v[28:31], v[128:131], v[212:215]
    ds_read_b64 v[28:29], v218 offset:2048
    v_mfma_f32_16x16x32_bf16 v[200:203], v[32:35], v[112:115], v[200:203]
    ds_read_b64 v[30:31], v218 offset:2056
    v_mfma_f32_16x16x32_bf16 v[204:207], v[32:35], v[116:119], v[204:207]
    v_mfma_f32_16x16x32_bf16 v[208:211], v[32:35], v[120:123], v[208:211]
    v_mfma_f32_16x16x32_bf16 v[212:215], v[32:35], v[124:127], v[212:215]
    ds_read_b64 v[32:33], v218 offset:1536
    s_waitcnt lgkmcnt(4)
    v_mfma_f32_16x16x32_bf16 v[204:207], v[36:39], v[112:115], v[204:207]
    ds_read_b64 v[34:35], v218 offset:1544
    v_mfma_f32_16x16x32_bf16 v[208:211], v[36:39], v[116:119], v[208:211]
    v_mfma_f32_16x16x32_bf16 v[212:215], v[36:39], v[120:123], v[212:215]
    ds_read_b64 v[36:37], v218 offset:1024
    v_mfma_f32_16x16x32_bf16 v[208:211], v[40:43], v[112:115], v[208:211]
    ds_read_b64 v[38:39], v218 offset:1032
    v_mfma_f32_16x16x32_bf16 v[212:215], v[40:43], v[116:119], v[212:215]
    ds_read_b64 v[40:41], v218 offset:512
    v_mfma_f32_16x16x32_bf16 v[212:215], v[44:47], v[112:115], v[212:215]
    ds_read_b64 v[42:43], v218 offset:520
    v_mfma_f32_16x16x32_bf16 v[184:187], v[16:19], v[144:147], v[184:187]
    ds_read_b64 v[44:45], v218 offset:0
    v_mfma_f32_16x16x32_bf16 v[188:191], v[16:19], v[148:151], v[188:191]
    ds_read_b64 v[46:47], v218 offset:8
    v_mfma_f32_16x16x32_bf16 v[192:195], v[16:19], v[152:155], v[192:195]
    v_mfma_f32_16x16x32_bf16 v[196:199], v[16:19], v[156:159], v[196:199]
    v_mfma_f32_16x16x32_bf16 v[200:203], v[16:19], v[160:163], v[200:203]
    v_mfma_f32_16x16x32_bf16 v[204:207], v[16:19], v[164:167], v[204:207]
    v_mfma_f32_16x16x32_bf16 v[208:211], v[16:19], v[168:171], v[208:211]
    v_mfma_f32_16x16x32_bf16 v[212:215], v[16:19], v[172:175], v[212:215]
    v_mfma_f32_16x16x32_bf16 v[188:191], v[20:23], v[144:147], v[188:191]
    v_mfma_f32_16x16x32_bf16 v[192:195], v[20:23], v[148:151], v[192:195]
    v_mfma_f32_16x16x32_bf16 v[196:199], v[20:23], v[152:155], v[196:199]
    v_mfma_f32_16x16x32_bf16 v[200:203], v[20:23], v[156:159], v[200:203]
    v_mfma_f32_16x16x32_bf16 v[204:207], v[20:23], v[160:163], v[204:207]
    v_mfma_f32_16x16x32_bf16 v[208:211], v[20:23], v[164:167], v[208:211]
    v_mfma_f32_16x16x32_bf16 v[212:215], v[20:23], v[168:171], v[212:215]
    s_waitcnt lgkmcnt(4)
    v_mfma_f32_16x16x32_bf16 v[192:195], v[24:27], v[144:147], v[192:195]
    v_mfma_f32_16x16x32_bf16 v[196:199], v[24:27], v[148:151], v[196:199]
    v_mfma_f32_16x16x32_bf16 v[200:203], v[24:27], v[152:155], v[200:203]
    v_mfma_f32_16x16x32_bf16 v[204:207], v[24:27], v[156:159], v[204:207]
    v_mfma_f32_16x16x32_bf16 v[208:211], v[24:27], v[160:163], v[208:211]
    v_mfma_f32_16x16x32_bf16 v[212:215], v[24:27], v[164:167], v[212:215]
    v_mfma_f32_16x16x32_bf16 v[196:199], v[28:31], v[144:147], v[196:199]
    v_mfma_f32_16x16x32_bf16 v[200:203], v[28:31], v[148:151], v[200:203]
    v_mfma_f32_16x16x32_bf16 v[204:207], v[28:31], v[152:155], v[204:207]
    v_mfma_f32_16x16x32_bf16 v[208:211], v[28:31], v[156:159], v[208:211]
    v_mfma_f32_16x16x32_bf16 v[212:215], v[28:31], v[160:163], v[212:215]
    v_mfma_f32_16x16x32_bf16 v[200:203], v[32:35], v[144:147], v[200:203]
    v_mfma_f32_16x16x32_bf16 v[204:207], v[32:35], v[148:151], v[204:207]
    v_mfma_f32_16x16x32_bf16 v[208:211], v[32:35], v[152:155], v[208:211]
    v_mfma_f32_16x16x32_bf16 v[212:215], v[32:35], v[156:159], v[212:215]
    v_mfma_f32_16x16x32_bf16 v[204:207], v[36:39], v[144:147], v[204:207]
    v_mfma_f32_16x16x32_bf16 v[208:211], v[36:39], v[148:151], v[208:211]
    v_mfma_f32_16x16x32_bf16 v[212:215], v[36:39], v[152:155], v[212:215]
    s_waitcnt lgkmcnt(2)
    v_mfma_f32_16x16x32_bf16 v[208:211], v[40:43], v[144:147], v[208:211]
    v_mfma_f32_16x16x32_bf16 v[212:215], v[40:43], v[148:151], v[212:215]
    s_waitcnt lgkmcnt(0)
    v_mfma_f32_16x16x32_bf16 v[212:215], v[44:47], v[144:147], v[212:215]
    s_nop 7
    s_nop 3
    s_cmp_lt_u32 s24, 6
    s_cbranch_scc1 KF_CX0
    ds_write_b128 v221, v[184:187] offset:0
    ds_write_b128 v221, v[188:191] offset:1056
    ds_write_b128 v221, v[192:195] offset:2112
    ds_write_b128 v221, v[196:199] offset:3168
    v_mov_b32 v184, v200
    v_mov_b32 v185, v201
    v_mov_b32 v186, v202
    v_mov_b32 v187, v203
    v_mov_b32 v188, v204
    v_mov_b32 v189, v205
    v_mov_b32 v190, v206
    v_mov_b32 v191, v207
    v_mov_b32 v192, v208
    v_mov_b32 v193, v209
    v_mov_b32 v194, v210
    v_mov_b32 v195, v211
    v_mov_b32 v196, v212
    v_mov_b32 v197, v213
    v_mov_b32 v198, v214
    v_mov_b32 v199, v215
    s_branch KF_CX1
KF_CX0:
    ds_write_b128 v221, v[200:203] offset:0
    ds_write_b128 v221, v[204:207] offset:1056
    ds_write_b128 v221, v[208:211] offset:2112
    ds_write_b128 v221, v[212:215] offset:3168
KF_CX1:
    s_branch KF_ATT1
KF_ATT0:
    s_barrier
    s_waitcnt vmcnt(0)
    s_cmp_eq_u32 s69, 0
    s_cbranch_scc1 KF_FG
    v_mov_b32 v176, 0
    v_mov_b32 v177, s66
    s_mov_b64 exec, 1
    buffer_store_dword v177, v176, s[20:23], s68 offen
    s_mov_b64 exec, -1
    s_branch KF_FG2
KF_FG:
    v_mov_b32 v176, 0
    v_mov_b32 v177, s66
    s_mov_b64 exec, 1
    buffer_store_dword v177, v176, s[20:23], s68 offen sc0 sc1
    s_mov_b64 exec, -1
KF_FG2:
    v_mov_b32 v217, 0
    s_cmp_lt_u32 s24, 2
    s_cbranch_scc1 KF_NG
    s_lshl_b32 s53, s59, 4
    s_add_u32 s53, s53, 17825792
    v_mov_b32 v204, 0
    s_mov_b32 exec_lo, 0
    s_mov_b32 exec_hi, 0x80000000
    buffer_store_dwordx4 v[208:211], v204, s[20:23], s53 offen sc1
    s_mov_b64 exec, -1
KF_NG:
    s_load_dwordx2 s[40:41], s[0:1], 16
    s_load_dwordx2 s[42:43], s[0:1], 104
    s_lshl_b32 s44, s25, 10
    s_lshl_b32 s45, s26, 5
    s_add_u32 s44, s44, s45
    s_add_u32 s44, s44, 18055168
    s_lshl_b32 s45, s3, 5
    s_add_u32 s45, s45, 18022400
    s_and_b32 s25, s2, 7
    s_lshl_b32 s25, s25, 2
    s_bfe_u32 s26, s2, 0x20003
    s_add_u32 s25, s25, s26
    s_lshr_b32 s26, s2, 5
    s_lshl_b32 s27, s25, 16
    s_and_b32 s36, s24, 3
    s_lshr_b32 s37, s24, 2
    s_lshl_b32 s28, s26, 3
    s_lshl_b32 s29, s36, 1
    s_add_u32 s28, s28, s29
    v_lshlrev_b32 v7, 4, v1
    s_lshl_b32 s30, s37, 5
    s_add_u32 s30, s30, s36
    s_mul_i32 s38, s30, 1056
    s_add_u32 s38, s38, 65536
    s_lshl_b32 s30, s30, 10
    s_add_u32 s31, s27, s30
    s_add_u32 s32, s31, 4194304
    s_add_u32 s31, s31, 2097152
    s_mov_b32 s46, 0
    v_and_b32 v81, 31, v1
    v_lshrrev_b32 v82, 5, v1
    s_lshl_b32 s53, s37, 15
    v_add_u32 v2, s53, v7
    s_mul_i32 s53, s37, 33792
    s_add_u32 s53, s53, 65536
    v_lshlrev_b32 v83, 8, v82
    v_and_b32 v86, 15, v1
    v_lshl_add_u32 v83, v86, 4, v83
    v_and_b32 v86, 27, v1
    v_cmp_eq_u32 vcc, 16, v86
    v_mov_b32 v86, 1040
    v_mov_b32 v87, 1024
    v_cndmask_b32 v86, v86, v87, vcc
    v_cmp_gt_u32 vcc, 16, v81
    v_subrev_u32 v87, 512, v86
    v_lshrrev_b32 v5, 3, v1
    v_cndmask_b32 v3, v86, v83, vcc
    v_cndmask_b32 v4, v87, v83, vcc
    v_add_u32 v3, s53, v3
    v_add_u32 v4, s53, v4
    v_bfe_u32 v86, v1, 4, 1
    v_lshlrev_b32 v86, 2, v86
    v_xor_b32 v86, v86, v1
    v_and_b32 v86, 7, v86
    v_lshlrev_b32 v6, 12, v5
    v_lshlrev_b32 v5, 10, v5
    v_lshl_add_u32 v5, v86, 4, v5
    v_lshl_add_u32 v6, v86, 4, v6
    s_lshl_b32 s53, s26, 10
    s_add_u32 s53, s53, 18022400
    s_lshl_b32 s54, s25, 10
    s_add_u32 s54, s54, 18055168
    v_lshlrev_b32 v86, 5, v81
    v_add_u32 v86, s53, v86
    v_and_b32 v87, 7, v1
    v_lshlrev_b32 v87, 5, v87
    v_add_u32 v87, s54, v87
    v_cmp_gt_u32 vcc, 32, v1
    v_lshlrev_b32 v229, 2, v1
    v_lshlrev_b32 v241, 2, v1
    v_add_u32 v245, 2097152, v7
    v_and_b32 v246, 0x7c, v229
    v_lshlrev_b32 v242, 2, v1
    s_lshl_b32 s47, s24, 10
    v_cndmask_b32 v227, v87, v86, vcc
    s_lshl_b32 s48, s24, 13
    s_lshl_b32 s49, s26, 7
    s_add_u32 s48, s48, s49
    s_mov_b32 s49, 0
    s_and_b32 s53, s24, 1
    v_lshrrev_b32 v80, 4, v1
    v_bfe_u32 v81, v1, 2, 2
    v_lshrrev_b32 v82, 1, v80
    v_lshlrev_b32 v82, 4, v82
    v_and_b32 v83, 1, v80
    v_lshl_add_u32 v82, v83, 2, v82
    v_add_u32 v82, v82, v81
    v_lshlrev_b32 v82, 7, v82
    v_lshrrev_b32 v83, 1, v81
    v_lshlrev_b32 v83, 6, v83
    v_and_b32 v84, 3, v1
    v_lshlrev_b32 v84, 3, v84
    s_lshr_b32 s54, s24, 1
    s_lshl_b32 s54, s54, 5
    v_add_u32 v232, s54, v84
    v_xor_b32 v232, v232, v83
    v_add_u32 v232, v232, v82
    v_lshl_add_u32 v233, v80, 2, v81
    v_lshlrev_b32 v233, 7, v233
    s_lshl_b32 s54, s53, 6
    v_add_u32 v85, s54, v84
    v_xor_b32 v85, v85, v83
    v_add_u32 v233, v233, v85
    s_lshr_b32 s54, s24, 1
    s_lshl_b32 s54, s54, 11
    s_add_u32 s54, s54, 133120
    v_add_u32 v233, s54, v233
    v_lshlrev_b32 v234, 9, v80
    v_and_b32 v85, 15, v1
    v_lshl_add_u32 v234, v85, 4, v234
    s_lshl_b32 s54, s53, 12
    v_add_u32 v234, s54, v234
    v_add_u32 v235, 82432, v234
    v_lshlrev_b32 v236, 10, v85
    v_lshl_add_u32 v236, v80, 3, v236
    s_mul_i32 s53, s24, 2176
    s_add_u32 s53, s53, 145408
    s_xor_b32 s54, s24, 4
    s_mul_i32 s54, s54, 2176
    s_add_u32 s54, s54, 145408
    v_add_u32 v237, s53, v7
    v_add_u32 v238, s54, v7
    v_and_b32 v239, 0x7c, v229
    v_add_u32 v240, s54, v239
    v_add_u32 v239, s53, v239
    s_waitcnt lgkmcnt(0)
    s_mov_b32 s4, s40
    s_and_b32 s5, s41, 0xffff
    s_mov_b32 s6, 0x80000
    s_mov_b32 s7, 0x00020000
    s_mov_b32 s8, s42
    s_and_b32 s9, s43, 0xffff
    s_mov_b32 s10, 0x200000
    s_mov_b32 s11, 0x00020000
    v_lshrrev_b32 v179, 3, v1
    s_lshl_b32 s53, s36, 3
    v_add_u32 v179, s53, v179
    v_mul_u32_u24 v179, 1056, v179
    v_and_b32 v182, 7, v1
    v_lshl_add_u32 v179, v182, 2, v179
    v_add_u32 v179, 66560, v179
    v_cmp_gt_u32 vcc, 4, v182
    v_mov_b32 v183, 0x3f803f80
    s_nop 0
    v_cndmask_b32 v183, 0, v183, vcc
    ds_write_b32 v179, v183
    ds_write_b32 v179, v183 offset:33792
    v_mov_b32 v56, 0
    v_mov_b32 v57, 0
    v_mov_b32 v58, 0
    v_mov_b32 v59, 0
    v_mov_b32 v60, 0
    v_mov_b32 v61, 0
    v_mov_b32 v62, 0
    v_mov_b32 v63, 0
    v_mov_b32 v64, 0
    v_mov_b32 v65, 0
    v_mov_b32 v66, 0
    v_mov_b32 v67, 0
    v_mov_b32 v68, 0
    v_mov_b32 v69, 0
    v_mov_b32 v70, 0
    v_mov_b32 v71, 0
    v_mov_b32 v72, 0
    v_mov_b32 v73, 0
    v_mov_b32 v74, 0
    v_mov_b32 v75, 0
    v_mov_b32 v76, 0
    v_mov_b32 v77, 0
    v_mov_b32 v78, 0
    v_mov_b32 v79, 0
    v_mov_b32 v80, 0
    v_mov_b32 v81, 0
    v_mov_b32 v82, 0
    v_mov_b32 v83, 0
    v_mov_b32 v84, 0
    v_mov_b32 v85, 0
    v_mov_b32 v86, 0
    v_mov_b32 v87, 0
    v_mov_b32 v52, 0
    v_mov_b32 v53, 0
    v_mov_b32 v54, 0
    v_mov_b32 v55, 0
    v_mov_b32 v108, 0
    v_mov_b32 v109, 0
    v_mov_b32 v110, 0
    v_mov_b32 v111, 0
    s_lshr_b32 s53, s25, 1
    s_lshl_b32 s53, s53, 8
    s_add_u32 s53, s53, 18087936
    v_mov_b32 v178, 162832
    s_cmp_lg_u32 s24, 0
    s_cbranch_scc1 KF_QW
    s_mov_b32 s67, 400000
PL2:
    buffer_load_dword v176, v241, s[20:23], s53 offen sc1
    s_sub_u32 s67, s67, 1
    s_waitcnt vmcnt(0)
    v_cmp_ne_u32 vcc, s66, v176
    s_cmp_eq_u32 s67, 0
    s_cbranch_scc1 PL2_X
    s_cbranch_vccz PL2_X
    s_sleep 2
    s_branch PL2
PL2_X:
    v_mov_b32 v179, s66
    s_mov_b64 exec, 1
    ds_write_b32 v178, v179
    s_mov_b64 exec, -1
    s_branch KF_QGO
KF_QW:
    s_sleep 1
    ds_read_b32 v179, v178
    s_waitcnt lgkmcnt(0)
    v_readfirstlane_b32 s53, v179
    s_nop 0
    s_cmp_eq_u32 s53, s66
    s_cbranch_scc0 KF_QW
KF_QGO:
    s_lshl_b32 s29, s28, 10
    s_add_u32 s29, s29, s27
    s_lshl_b32 s53, s36, 11
    s_add_u32 m0, s53, 133120
    s_nop 0
    buffer_load_dwordx4 v7, s[20:23], s29 offen sc1 lds
    buffer_load_dwordx4 v7, s[20:23], s29 offen offset:1024 sc1 lds
    s_add_u32 m0, s30, 32768
    s_add_u32 s53, s31, 32768
    buffer_load_dwordx4 v7, s[20:23], s53 offen sc1 lds
    s_add_u32 m0, s38, 33792
    s_add_u32 s53, s32, 32768
    buffer_load_dwordx4 v7, s[20:23], s53 offen sc1 lds
    s_mov_b32 m0, s30
    s_add_u32 s30, s30, 4096
    buffer_load_dwordx4 v7, s[20:23], s31 offen sc1 lds
    s_mov_b32 m0, s38
    s_add_u32 s38, s38, 4224
    buffer_load_dwordx4 v7, s[20:23], s32 offen sc1 lds
    s_add_u32 s31, s31, 4096
    s_add_u32 s32, s32, 4096
    s_lshl_b32 s53, s24, 2
    s_add_u32 s53, s53, 162880
    v_mov_b32 v178, s53
    v_mov_b32 v179, s66
    s_waitcnt vmcnt(0) lgkmcnt(0)
    s_mov_b64 exec, 1
    ds_write_b32 v178, v179
    s_mov_b64 exec, -1
KF_ATT1:
    v_and_b32 v178, 12, v229
    v_add_u32 v178, 162880, v178
KF_KW:
    s_sleep 1
    ds_read_b32 v179, v178
    s_waitcnt lgkmcnt(0)
    v_cmp_ne_u32 vcc, s66, v179
    s_nop 1
    s_cbranch_vccnz KF_KW
    s_setprio 3
    s_mov_b32 s39, 0x07060302
    s_lshl_b32 s53, s36, 11
    s_add_u32 s53, s53, 133120
    v_add_u32 v176, s53, v7
    ds_read_b128 v[8:11], v176
    ds_read_b128 v[12:15], v176 offset:1024
    v_mov_b32 v32, 0
    v_mov_b32 v33, 0
    v_mov_b32 v34, 0
    v_mov_b32 v35, 0
    v_mov_b32 v36, 0
    v_mov_b32 v37, 0
    v_mov_b32 v38, 0
    v_mov_b32 v39, 0
    v_mov_b32 v40, 0
    v_mov_b32 v41, 0
    v_mov_b32 v42, 0
    v_mov_b32 v43, 0
    v_mov_b32 v44, 0
    v_mov_b32 v45, 0
    v_mov_b32 v46, 0
    v_mov_b32 v47, 0
    v_mov_b32 v104, 0
    v_mov_b32 v105, 0
    v_mov_b32 v106, 0
    v_mov_b32 v107, 0
    v_mov_b32 v48, 0xdddddddd
    ds_read_b128 v[88:91], v2
    ds_read_b128 v[96:99], v3
    ds_read_b128 v[100:103], v4 offset:512
    s_waitcnt lgkmcnt(2)
    v_mfma_f32_32x32x16_bf16 v[16:31], v[88:91], v[8:11], 0
    s_waitcnt lgkmcnt(0)
    s_nop 7
    s_nop 3
.p2align 6
    v_exp_f32 v16, v16
    v_exp_f32 v17, v17
    v_smfmac_f32_32x32x32_bf16 v[72:87], v[108:111], v[40:47], v48
    s_add_u32 m0, s30, 0
    s_add_u32 s53, s31, 0
    v_exp_f32 v18, v18
    v_exp_f32 v19, v19
    v_exp_f32 v20, v20
    v_mfma_f32_32x32x16_bf16 v[32:47], v[88:91], v[12:15], 0
    ds_read_b128 v[92:95], v2 offset:1024
    ds_read_b128 v[104:107], v3 offset:1056
    ds_read_b128 v[108:111], v4 offset:1568
    v_exp_f32 v21, v21
    v_exp_f32 v22, v22
    v_exp_f32 v23, v23
    v_exp_f32 v24, v24
    v_exp_f32 v25, v25
    v_exp_f32 v26, v26
    v_smfmac_f32_32x32x32_bf16 v[56:71], v[96:99], v[16:23], v48
    buffer_load_dwordx4 v7, s[20:23], s53 offen sc1 lds
    s_add_u32 m0, s38, 0
    v_exp_f32 v27, v27
    v_exp_f32 v28, v28
    v_exp_f32 v29, v29
    v_exp_f32 v30, v30
    v_exp_f32 v31, v31
    v_exp_f32 v32, v32
    v_exp_f32 v33, v33
    v_smfmac_f32_32x32x32_bf16 v[56:71], v[100:103], v[24:31], v48
    s_waitcnt lgkmcnt(0)
    v_exp_f32 v34, v34
    v_exp_f32 v35, v35
    v_exp_f32 v36, v36
    v_mfma_f32_32x32x16_bf16 v[16:31], v[92:95], v[8:11], 0
    s_setprio 2
    v_exp_f32 v37, v37
    v_exp_f32 v38, v38
    v_exp_f32 v39, v39
    v_exp_f32 v40, v40
    v_exp_f32 v41, v41
    v_exp_f32 v42, v42
    v_smfmac_f32_32x32x32_bf16 v[72:87], v[96:99], v[32:39], v48
    buffer_load_dwordx4 v245, s[20:23], s53 offen sc1 lds
    s_add_u32 m0, s30, 4096
    v_exp_f32 v43, v43
    v_exp_f32 v44, v44
    v_exp_f32 v45, v45
    v_exp_f32 v46, v46
    v_exp_f32 v47, v47
    v_exp_f32 v16, v16
    v_exp_f32 v17, v17
    v_smfmac_f32_32x32x32_bf16 v[72:87], v[100:103], v[40:47], v48
    s_add_u32 s53, s31, 4096
    buffer_load_dwordx4 v7, s[20:23], s53 offen sc1 lds
    v_exp_f32 v18, v18
    v_exp_f32 v19, v19
    v_exp_f32 v20, v20
    v_mfma_f32_32x32x16_bf16 v[32:47], v[92:95], v[12:15], 0
    ds_read_b128 v[88:91], v2 offset:2048
    ds_read_b128 v[96:99], v3 offset:2112
    ds_read_b128 v[100:103], v4 offset:2624
    v_exp_f32 v21, v21
    v_exp_f32 v22, v22
    v_exp_f32 v23, v23
    v_exp_f32 v24, v24
    v_exp_f32 v25, v25
    v_exp_f32 v26, v26
    v_smfmac_f32_32x32x32_bf16 v[56:71], v[104:107], v[16:23], v48
    s_add_u32 m0, s38, 4224
    s_nop 0
    buffer_load_dwordx4 v245, s[20:23], s53 offen sc1 lds
    v_exp_f32 v27, v27
    v_exp_f32 v28, v28
    v_exp_f32 v29, v29
    v_exp_f32 v30, v30
    v_exp_f32 v31, v31
    v_exp_f32 v32, v32
    v_exp_f32 v33, v33
    v_smfmac_f32_32x32x32_bf16 v[56:71], v[108:111], v[24:31], v48
    s_waitcnt lgkmcnt(0)
    v_exp_f32 v34, v34
    v_exp_f32 v35, v35
    v_exp_f32 v36, v36
    v_mfma_f32_32x32x16_bf16 v[16:31], v[88:91], v[8:11], 0
    s_setprio 1
    v_exp_f32 v37, v37
    v_exp_f32 v38, v38
    v_exp_f32 v39, v39
    v_exp_f32 v40, v40
    v_exp_f32 v41, v41
    v_exp_f32 v42, v42
    v_smfmac_f32_32x32x32_bf16 v[72:87], v[104:107], v[32:39], v48
    s_lshl_b32 s12, s26, 16
    s_add_u32 s12, s12, s48
    v_exp_f32 v43, v43
    v_exp_f32 v44, v44
    v_exp_f32 v45, v45
    v_exp_f32 v46, v46
    v_exp_f32 v47, v47
    v_exp_f32 v16, v16
    v_exp_f32 v17, v17
    v_smfmac_f32_32x32x32_bf16 v[72:87], v[108:111], v[40:47], v48
    v_exp_f32 v18, v18
    v_exp_f32 v19, v19
    v_exp_f32 v20, v20
    v_mfma_f32_32x32x16_bf16 v[32:47], v[88:91], v[12:15], 0
    ds_read_b128 v[92:95], v2 offset:3072
    ds_read_b128 v[104:107], v3 offset:3168
    ds_read_b128 v[108:111], v4 offset:3680
    v_exp_f32 v21, v21
    v_exp_f32 v22, v22
    v_exp_f32 v23, v23
    v_exp_f32 v24, v24
    v_exp_f32 v25, v25
    v_exp_f32 v26, v26
    v_smfmac_f32_32x32x32_bf16 v[56:71], v[96:99], v[16:23], v48
    v_exp_f32 v27, v27
    v_exp_f32 v28, v28
    v_exp_f32 v29, v29
    v_exp_f32 v30, v30
    v_exp_f32 v31, v31
    v_exp_f32 v32, v32
    v_exp_f32 v33, v33
    v_smfmac_f32_32x32x32_bf16 v[56:71], v[100:103], v[24:31], v48
    s_waitcnt lgkmcnt(0)
    v_exp_f32 v34, v34
    v_exp_f32 v35, v35
    v_exp_f32 v36, v36
    v_mfma_f32_32x32x16_bf16 v[16:31], v[92:95], v[8:11], 0
    s_setprio 0
    v_exp_f32 v37, v37
    v_exp_f32 v38, v38
    v_exp_f32 v39, v39
    v_exp_f32 v40, v40
    v_exp_f32 v41, v41
    v_exp_f32 v42, v42
    v_smfmac_f32_32x32x32_bf16 v[72:87], v[96:99], v[32:39], v48
    s_waitcnt vmcnt(2)
    s_barrier
    s_cmp_lt_u32 s24, 4
    s_cbranch_scc0 KF_CF
KF_CFR:
    v_exp_f32 v43, v43
    v_exp_f32 v44, v44
    v_exp_f32 v45, v45
    v_exp_f32 v46, v46
    v_exp_f32 v47, v47
    v_exp_f32 v16, v16
    v_exp_f32 v17, v17
    v_smfmac_f32_32x32x32_bf16 v[72:87], v[100:103], v[40:47], v48
    s_setprio 3
    v_exp_f32 v18, v18
    v_exp_f32 v19, v19
    v_exp_f32 v20, v20
    v_mfma_f32_32x32x16_bf16 v[32:47], v[92:95], v[12:15], 0
    ds_read_b128 v[88:91], v2 offset:4096
    ds_read_b128 v[96:99], v3 offset:4224
    ds_read_b128 v[100:103], v4 offset:4736
    v_exp_f32 v21, v21
    v_exp_f32 v22, v22
    v_exp_f32 v23, v23
    v_exp_f32 v24, v24
    v_exp_f32 v25, v25
    v_exp_f32 v26, v26
    v_smfmac_f32_32x32x32_bf16 v[56:71], v[104:107], v[16:23], v48
    s_add_u32 m0, s30, 8192
    v_exp_f32 v27, v27
    v_exp_f32 v28, v28
    v_exp_f32 v29, v29
    v_exp_f32 v30, v30
    v_exp_f32 v31, v31
    v_exp_f32 v32, v32
    v_exp_f32 v33, v33
    v_smfmac_f32_32x32x32_bf16 v[56:71], v[108:111], v[24:31], v48
    s_waitcnt lgkmcnt(0)
    v_exp_f32 v34, v34
    v_exp_f32 v35, v35
    v_exp_f32 v36, v36
    v_mfma_f32_32x32x16_bf16 v[16:31], v[88:91], v[8:11], 0
    s_add_u32 s53, s31, 8192
    v_exp_f32 v37, v37
    v_exp_f32 v38, v38
    v_exp_f32 v39, v39
    v_exp_f32 v40, v40
    v_exp_f32 v41, v41
    v_exp_f32 v42, v42
    v_smfmac_f32_32x32x32_bf16 v[72:87], v[104:107], v[32:39], v48
    buffer_load_dwordx4 v7, s[20:23], s53 offen sc1 lds
    v_exp_f32 v43, v43
    v_exp_f32 v44, v44
    v_exp_f32 v45, v45
    v_exp_f32 v46, v46
    v_exp_f32 v47, v47
    v_exp_f32 v16, v16
    v_exp_f32 v17, v17
    v_smfmac_f32_32x32x32_bf16 v[72:87], v[108:111], v[40:47], v48
    s_add_u32 m0, s38, 8448
    v_exp_f32 v18, v18
    v_exp_f32 v19, v19
    v_exp_f32 v20, v20
    v_mfma_f32_32x32x16_bf16 v[32:47], v[88:91], v[12:15], 0
    ds_read_b128 v[92:95], v2 offset:5120
    ds_read_b128 v[104:107], v3 offset:5280
    ds_read_b128 v[108:111], v4 offset:5792
    v_exp_f32 v21, v21
    v_exp_f32 v22, v22
    v_exp_f32 v23, v23
    v_exp_f32 v24, v24
    v_exp_f32 v25, v25
    v_exp_f32 v26, v26
    v_smfmac_f32_32x32x32_bf16 v[56:71], v[96:99], v[16:23], v48
    buffer_load_dwordx4 v245, s[20:23], s53 offen sc1 lds
    v_exp_f32 v27, v27
    v_exp_f32 v28, v28
    v_exp_f32 v29, v29
    v_exp_f32 v30, v30
    v_exp_f32 v31, v31
    v_exp_f32 v32, v32
    v_exp_f32 v33, v33
    v_smfmac_f32_32x32x32_bf16 v[56:71], v[100:103], v[24:31], v48
    s_waitcnt lgkmcnt(0)
    v_exp_f32 v34, v34
    v_exp_f32 v35, v35
    v_exp_f32 v36, v36
    v_mfma_f32_32x32x16_bf16 v[16:31], v[92:95], v[8:11], 0
    s_setprio 2
    v_exp_f32 v37, v37
    v_exp_f32 v38, v38
    v_exp_f32 v39, v39
    v_exp_f32 v40, v40
    v_exp_f32 v41, v41
    v_exp_f32 v42, v42
    v_smfmac_f32_32x32x32_bf16 v[72:87], v[96:99], v[32:39], v48
    s_lshr_b32 s39, s2, 3
    v_exp_f32 v43, v43
    v_exp_f32 v44, v44
    v_exp_f32 v45, v45
    v_exp_f32 v46, v46
    v_exp_f32 v47, v47
    v_exp_f32 v16, v16
    v_exp_f32 v17, v17
    v_smfmac_f32_32x32x32_bf16 v[72:87], v[100:103], v[40:47], v48
    s_add_u32 s39, s39, s24
    v_exp_f32 v18, v18
    v_exp_f32 v19, v19
    v_exp_f32 v20, v20
    v_mfma_f32_32x32x16_bf16 v[32:47], v[92:95], v[12:15], 0
    ds_read_b128 v[88:91], v2 offset:6144
    ds_read_b128 v[96:99], v3 offset:6336
    ds_read_b128 v[100:103], v4 offset:6848
    v_exp_f32 v21, v21
    v_exp_f32 v22, v22
    v_exp_f32 v23, v23
    v_exp_f32 v24, v24
    v_exp_f32 v25, v25
    v_exp_f32 v26, v26
    v_smfmac_f32_32x32x32_bf16 v[56:71], v[104:107], v[16:23], v48
    s_lshl_b32 s64, s26, 18
    v_exp_f32 v27, v27
    v_exp_f32 v28, v28
    v_exp_f32 v29, v29
    v_exp_f32 v30, v30
    v_exp_f32 v31, v31
    v_exp_f32 v32, v32
    v_exp_f32 v33, v33
    v_smfmac_f32_32x32x32_bf16 v[56:71], v[108:111], v[24:31], v48
    s_waitcnt lgkmcnt(0)
    v_exp_f32 v34, v34
    v_exp_f32 v35, v35
    v_exp_f32 v36, v36
    v_mfma_f32_32x32x16_bf16 v[16:31], v[88:91], v[8:11], 0
    s_setprio 1
    v_exp_f32 v37, v37
    v_exp_f32 v38, v38
    v_exp_f32 v39, v39
    v_exp_f32 v40, v40
    v_exp_f32 v41, v41
    v_exp_f32 v42, v42
    v_smfmac_f32_32x32x32_bf16 v[72:87], v[104:107], v[32:39], v48
    s_lshl_b32 s54, s25, 7
    v_exp_f32 v43, v43
    v_exp_f32 v44, v44
    v_exp_f32 v45, v45
    v_exp_f32 v46, v46
    v_exp_f32 v47, v47
    v_exp_f32 v16, v16
    v_exp_f32 v17, v17
    v_smfmac_f32_32x32x32_bf16 v[72:87], v[108:111], v[40:47], v48
    s_add_u32 s64, s64, s54
    v_exp_f32 v18, v18
    v_exp_f32 v19, v19
    v_exp_f32 v20, v20
    v_mfma_f32_32x32x16_bf16 v[32:47], v[88:91], v[12:15], 0
    ds_read_b128 v[92:95], v2 offset:7168
    ds_read_b128 v[104:107], v3 offset:7392
    ds_read_b128 v[108:111], v4 offset:7904
    v_exp_f32 v21, v21
    v_exp_f32 v22, v22
    v_exp_f32 v23, v23
    v_exp_f32 v24, v24
    v_exp_f32 v25, v25
    v_exp_f32 v26, v26
    v_smfmac_f32_32x32x32_bf16 v[56:71], v[96:99], v[16:23], v48
    s_lshl_b32 s54, s24, 15
    v_exp_f32 v27, v27
    v_exp_f32 v28, v28
    v_exp_f32 v29, v29
    v_exp_f32 v30, v30
    v_exp_f32 v31, v31
    v_exp_f32 v32, v32
    v_exp_f32 v33, v33
    v_smfmac_f32_32x32x32_bf16 v[56:71], v[100:103], v[24:31], v48
    s_waitcnt lgkmcnt(0)
    v_exp_f32 v34, v34
    v_exp_f32 v35, v35
    v_exp_f32 v36, v36
    v_mfma_f32_32x32x16_bf16 v[16:31], v[92:95], v[8:11], 0
    s_setprio 0
    v_exp_f32 v37, v37
    v_exp_f32 v38, v38
    v_exp_f32 v39, v39
    v_exp_f32 v40, v40
    v_exp_f32 v41, v41
    v_exp_f32 v42, v42
    v_smfmac_f32_32x32x32_bf16 v[72:87], v[96:99], v[32:39], v48
    s_waitcnt vmcnt(0)
    s_barrier
    s_cmp_eq_u32 s24, 0
    s_cbranch_scc1 KF_BF
KF_BFR:
    v_exp_f32 v43, v43
    v_exp_f32 v44, v44
    v_exp_f32 v45, v45
    v_exp_f32 v46, v46
    v_exp_f32 v47, v47
    v_exp_f32 v16, v16
    v_exp_f32 v17, v17
    v_smfmac_f32_32x32x32_bf16 v[72:87], v[100:103], v[40:47], v48
    s_setprio 3
    v_exp_f32 v18, v18
    v_exp_f32 v19, v19
    v_exp_f32 v20, v20
    v_mfma_f32_32x32x16_bf16 v[32:47], v[92:95], v[12:15], 0
    ds_read_b128 v[88:91], v2 offset:8192
    ds_read_b128 v[96:99], v3 offset:8448
    ds_read_b128 v[100:103], v4 offset:8960
    v_exp_f32 v21, v21
    v_exp_f32 v22, v22
    v_exp_f32 v23, v23
    v_exp_f32 v24, v24
    v_exp_f32 v25, v25
    v_exp_f32 v26, v26
    v_smfmac_f32_32x32x32_bf16 v[56:71], v[104:107], v[16:23], v48
    s_add_u32 m0, s30, 12288
    s_add_u32 s53, s31, 12288
    v_exp_f32 v27, v27
    v_exp_f32 v28, v28
    v_exp_f32 v29, v29
    v_exp_f32 v30, v30
    v_exp_f32 v31, v31
    v_exp_f32 v32, v32
    v_exp_f32 v33, v33
    v_smfmac_f32_32x32x32_bf16 v[56:71], v[108:111], v[24:31], v48
    s_waitcnt lgkmcnt(0)
    v_exp_f32 v34, v34
    v_exp_f32 v35, v35
    v_exp_f32 v36, v36
    v_mfma_f32_32x32x16_bf16 v[16:31], v[88:91], v[8:11], 0
    buffer_load_dwordx4 v7, s[20:23], s53 offen sc1 lds
    s_add_u32 m0, s38, 12672
    v_exp_f32 v37, v37
    v_exp_f32 v38, v38
    v_exp_f32 v39, v39
    v_exp_f32 v40, v40
    v_exp_f32 v41, v41
    v_exp_f32 v42, v42
    v_smfmac_f32_32x32x32_bf16 v[72:87], v[104:107], v[32:39], v48
    buffer_load_dwordx4 v245, s[20:23], s53 offen sc1 lds
    s_add_u32 m0, s30, 16384
    v_exp_f32 v43, v43
    v_exp_f32 v44, v44
    v_exp_f32 v45, v45
    v_exp_f32 v46, v46
    v_exp_f32 v47, v47
    v_exp_f32 v16, v16
    v_exp_f32 v17, v17
    v_smfmac_f32_32x32x32_bf16 v[72:87], v[108:111], v[40:47], v48
    s_add_u32 s53, s31, 16384
    buffer_load_dwordx4 v7, s[20:23], s53 offen sc1 lds
    v_exp_f32 v18, v18
    v_exp_f32 v19, v19
    v_exp_f32 v20, v20
    v_mfma_f32_32x32x16_bf16 v[32:47], v[88:91], v[12:15], 0
    ds_read_b128 v[92:95], v2 offset:9216
    ds_read_b128 v[104:107], v3 offset:9504
    ds_read_b128 v[108:111], v4 offset:10016
    v_exp_f32 v21, v21
    v_exp_f32 v22, v22
    v_exp_f32 v23, v23
    v_exp_f32 v24, v24
    v_exp_f32 v25, v25
    v_exp_f32 v26, v26
    v_smfmac_f32_32x32x32_bf16 v[56:71], v[96:99], v[16:23], v48
    s_add_u32 m0, s38, 16896
    s_nop 0
    buffer_load_dwordx4 v245, s[20:23], s53 offen sc1 lds
    v_exp_f32 v27, v27
    v_exp_f32 v28, v28
    v_exp_f32 v29, v29
    v_exp_f32 v30, v30
    v_exp_f32 v31, v31
    v_exp_f32 v32, v32
    v_exp_f32 v33, v33
    v_smfmac_f32_32x32x32_bf16 v[56:71], v[100:103], v[24:31], v48
    s_waitcnt lgkmcnt(0)
    v_exp_f32 v34, v34
    v_exp_f32 v35, v35
    v_exp_f32 v36, v36
    v_mfma_f32_32x32x16_bf16 v[16:31], v[92:95], v[8:11], 0
    s_setprio 2
    v_exp_f32 v37, v37
    v_exp_f32 v38, v38
    v_exp_f32 v39, v39
    v_exp_f32 v40, v40
    v_exp_f32 v41, v41
    v_exp_f32 v42, v42
    v_smfmac_f32_32x32x32_bf16 v[72:87], v[96:99], v[32:39], v48
    s_add_u32 m0, s30, 20480
    s_add_u32 s53, s31, 20480
    v_exp_f32 v43, v43
    v_exp_f32 v44, v44
    v_exp_f32 v45, v45
    v_exp_f32 v46, v46
    v_exp_f32 v47, v47
    v_exp_f32 v16, v16
    v_exp_f32 v17, v17
    v_smfmac_f32_32x32x32_bf16 v[72:87], v[100:103], v[40:47], v48
    buffer_load_dwordx4 v7, s[20:23], s53 offen sc1 lds
    s_add_u32 m0, s38, 21120
    v_exp_f32 v18, v18
    v_exp_f32 v19, v19
    v_exp_f32 v20, v20
    v_mfma_f32_32x32x16_bf16 v[32:47], v[92:95], v[12:15], 0
    ds_read_b128 v[88:91], v2 offset:10240
    ds_read_b128 v[96:99], v3 offset:10560
    ds_read_b128 v[100:103], v4 offset:11072
    v_exp_f32 v21, v21
    v_exp_f32 v22, v22
    v_exp_f32 v23, v23
    v_exp_f32 v24, v24
    v_exp_f32 v25, v25
    v_exp_f32 v26, v26
    v_smfmac_f32_32x32x32_bf16 v[56:71], v[104:107], v[16:23], v48
    buffer_load_dwordx4 v245, s[20:23], s53 offen sc1 lds
    s_add_u32 m0, s30, 24576
    v_exp_f32 v27, v27
    v_exp_f32 v28, v28
    v_exp_f32 v29, v29
    v_exp_f32 v30, v30
    v_exp_f32 v31, v31
    v_exp_f32 v32, v32
    v_exp_f32 v33, v33
    v_smfmac_f32_32x32x32_bf16 v[56:71], v[108:111], v[24:31], v48
    s_waitcnt lgkmcnt(0)
    v_exp_f32 v34, v34
    v_exp_f32 v35, v35
    v_exp_f32 v36, v36
    v_mfma_f32_32x32x16_bf16 v[16:31], v[88:91], v[8:11], 0
    s_setprio 1
    v_exp_f32 v37, v37
    v_exp_f32 v38, v38
    v_exp_f32 v39, v39
    v_exp_f32 v40, v40
    v_exp_f32 v41, v41
    v_exp_f32 v42, v42
    v_smfmac_f32_32x32x32_bf16 v[72:87], v[104:107], v[32:39], v48
    s_add_u32 s53, s31, 24576
    buffer_load_dwordx4 v7, s[20:23], s53 offen sc1 lds
    v_exp_f32 v43, v43
    v_exp_f32 v44, v44
    v_exp_f32 v45, v45
    v_exp_f32 v46, v46
    v_exp_f32 v47, v47
    v_exp_f32 v16, v16
    v_exp_f32 v17, v17
    v_smfmac_f32_32x32x32_bf16 v[72:87], v[108:111], v[40:47], v48
    s_add_u32 m0, s38, 25344
    v_exp_f32 v18, v18
    v_exp_f32 v19, v19
    v_exp_f32 v20, v20
    v_mfma_f32_32x32x16_bf16 v[32:47], v[88:91], v[12:15], 0
    ds_read_b128 v[92:95], v2 offset:11264
    ds_read_b128 v[104:107], v3 offset:11616
    ds_read_b128 v[108:111], v4 offset:12128
    v_exp_f32 v21, v21
    v_exp_f32 v22, v22
    v_exp_f32 v23, v23
    v_exp_f32 v24, v24
    v_exp_f32 v25, v25
    v_exp_f32 v26, v26
    v_smfmac_f32_32x32x32_bf16 v[56:71], v[96:99], v[16:23], v48
    buffer_load_dwordx4 v245, s[20:23], s53 offen sc1 lds
    v_exp_f32 v27, v27
    v_exp_f32 v28, v28
    v_exp_f32 v29, v29
    v_exp_f32 v30, v30
    v_exp_f32 v31, v31
    v_exp_f32 v32, v32
    v_exp_f32 v33, v33
    v_smfmac_f32_32x32x32_bf16 v[56:71], v[100:103], v[24:31], v48
    s_waitcnt lgkmcnt(0)
    v_exp_f32 v34, v34
    v_exp_f32 v35, v35
    v_exp_f32 v36, v36
    v_mfma_f32_32x32x16_bf16 v[16:31], v[92:95], v[8:11], 0
    s_setprio 0
    v_exp_f32 v37, v37
    v_exp_f32 v38, v38
    v_exp_f32 v39, v39
    v_exp_f32 v40, v40
    v_exp_f32 v41, v41
    v_exp_f32 v42, v42
    v_smfmac_f32_32x32x32_bf16 v[72:87], v[96:99], v[32:39], v48
    s_add_u32 s64, s64, s54
    v_exp_f32 v43, v43
    v_exp_f32 v44, v44
    v_exp_f32 v45, v45
    v_exp_f32 v46, v46
    v_exp_f32 v47, v47
    v_exp_f32 v16, v16
    v_exp_f32 v17, v17
    v_smfmac_f32_32x32x32_bf16 v[72:87], v[100:103], v[40:47], v48
    s_setprio 3
    v_exp_f32 v18, v18
    v_exp_f32 v19, v19
    v_exp_f32 v20, v20
    v_mfma_f32_32x32x16_bf16 v[32:47], v[92:95], v[12:15], 0
    ds_read_b128 v[88:91], v2 offset:12288
    ds_read_b128 v[96:99], v3 offset:12672
    ds_read_b128 v[100:103], v4 offset:13184
    v_exp_f32 v21, v21
    v_exp_f32 v22, v22
    v_exp_f32 v23, v23
    v_exp_f32 v24, v24
    v_exp_f32 v25, v25
    v_exp_f32 v26, v26
    v_smfmac_f32_32x32x32_bf16 v[56:71], v[104:107], v[16:23], v48
    s_add_u32 s64, s64, 15728640
    v_exp_f32 v27, v27
    v_exp_f32 v28, v28
    v_exp_f32 v29, v29
    v_exp_f32 v30, v30
    v_exp_f32 v31, v31
    v_exp_f32 v32, v32
    v_exp_f32 v33, v33
    v_smfmac_f32_32x32x32_bf16 v[56:71], v[108:111], v[24:31], v48
    s_waitcnt lgkmcnt(0)
    v_exp_f32 v34, v34
    v_exp_f32 v35, v35
    v_exp_f32 v36, v36
    v_mfma_f32_32x32x16_bf16 v[16:31], v[88:91], v[8:11], 0
    s_lshl_b32 s65, s25, 8
    v_exp_f32 v37, v37
    v_exp_f32 v38, v38
    v_exp_f32 v39, v39
    v_exp_f32 v40, v40
    v_exp_f32 v41, v41
    v_exp_f32 v42, v42
    v_smfmac_f32_32x32x32_bf16 v[72:87], v[104:107], v[32:39], v48
    s_and_b32 s54, s24, 1
    v_exp_f32 v43, v43
    v_exp_f32 v44, v44
    v_exp_f32 v45, v45
    v_exp_f32 v46, v46
    v_exp_f32 v47, v47
    v_exp_f32 v16, v16
    v_exp_f32 v17, v17
    v_smfmac_f32_32x32x32_bf16 v[72:87], v[108:111], v[40:47], v48
    s_lshl_b32 s54, s54, 7
    v_exp_f32 v18, v18
    v_exp_f32 v19, v19
    v_exp_f32 v20, v20
    v_mfma_f32_32x32x16_bf16 v[32:47], v[88:91], v[12:15], 0
    ds_read_b128 v[92:95], v2 offset:13312
    ds_read_b128 v[104:107], v3 offset:13728
    ds_read_b128 v[108:111], v4 offset:14240
    v_exp_f32 v21, v21
    v_exp_f32 v22, v22
    v_exp_f32 v23, v23
    v_exp_f32 v24, v24
    v_exp_f32 v25, v25
    v_exp_f32 v26, v26
    v_smfmac_f32_32x32x32_bf16 v[56:71], v[96:99], v[16:23], v48
    s_add_u32 s65, s65, s54
    v_exp_f32 v27, v27
    v_exp_f32 v28, v28
    v_exp_f32 v29, v29
    v_exp_f32 v30, v30
    v_exp_f32 v31, v31
    v_exp_f32 v32, v32
    v_exp_f32 v33, v33
    v_smfmac_f32_32x32x32_bf16 v[56:71], v[100:103], v[24:31], v48
    s_waitcnt lgkmcnt(0)
    v_exp_f32 v34, v34
    v_exp_f32 v35, v35
    v_exp_f32 v36, v36
    v_mfma_f32_32x32x16_bf16 v[16:31], v[92:95], v[8:11], 0
    s_setprio 2
    v_exp_f32 v37, v37
    v_exp_f32 v38, v38
    v_exp_f32 v39, v39
    v_exp_f32 v40, v40
    v_exp_f32 v41, v41
    v_exp_f32 v42, v42
    v_smfmac_f32_32x32x32_bf16 v[72:87], v[96:99], v[32:39], v48
    s_add_u32 s65, s65, 17825792
    v_exp_f32 v43, v43
    v_exp_f32 v44, v44
    v_exp_f32 v45, v45
    v_exp_f32 v46, v46
    v_exp_f32 v47, v47
    v_exp_f32 v16, v16
    v_exp_f32 v17, v17
    v_smfmac_f32_32x32x32_bf16 v[72:87], v[100:103], v[40:47], v48
    buffer_load_dword v228, v227, s[20:23], 0 offen sc0 sc1
    v_exp_f32 v18, v18
    v_exp_f32 v19, v19
    v_exp_f32 v20, v20
    v_mfma_f32_32x32x16_bf16 v[32:47], v[92:95], v[12:15], 0
    ds_read_b128 v[88:91], v2 offset:14336
    ds_read_b128 v[96:99], v3 offset:14784
    ds_read_b128 v[100:103], v4 offset:15296
    v_exp_f32 v21, v21
    v_exp_f32 v22, v22
    v_exp_f32 v23, v23
    v_exp_f32 v24, v24
    v_exp_f32 v25, v25
    v_exp_f32 v26, v26
    v_smfmac_f32_32x32x32_bf16 v[56:71], v[104:107], v[16:23], v48
    v_exp_f32 v27, v27
    v_exp_f32 v28, v28
    v_exp_f32 v29, v29
    v_exp_f32 v30, v30
    v_exp_f32 v31, v31
    v_exp_f32 v32, v32
    v_exp_f32 v33, v33
    v_smfmac_f32_32x32x32_bf16 v[56:71], v[108:111], v[24:31], v48
    s_waitcnt lgkmcnt(0)
    v_exp_f32 v34, v34
    v_exp_f32 v35, v35
    v_exp_f32 v36, v36
    v_mfma_f32_32x32x16_bf16 v[16:31], v[88:91], v[8:11], 0
    s_setprio 1
    v_exp_f32 v37, v37
    v_exp_f32 v38, v38
    v_exp_f32 v39, v39
    v_exp_f32 v40, v40
    v_exp_f32 v41, v41
    v_exp_f32 v42, v42
    v_smfmac_f32_32x32x32_bf16 v[72:87], v[104:107], v[32:39], v48
    v_exp_f32 v43, v43
    v_exp_f32 v44, v44
    v_exp_f32 v45, v45
    v_exp_f32 v46, v46
    v_exp_f32 v47, v47
    v_exp_f32 v16, v16
    v_exp_f32 v17, v17
    v_smfmac_f32_32x32x32_bf16 v[72:87], v[108:111], v[40:47], v48
    v_exp_f32 v18, v18
    v_exp_f32 v19, v19
    v_exp_f32 v20, v20
    v_mfma_f32_32x32x16_bf16 v[32:47], v[88:91], v[12:15], 0
    ds_read_b128 v[92:95], v2 offset:15360
    ds_read_b128 v[104:107], v3 offset:15840
    ds_read_b128 v[108:111], v4 offset:16352
    v_exp_f32 v21, v21
    v_exp_f32 v22, v22
    v_exp_f32 v23, v23
    v_exp_f32 v24, v24
    v_exp_f32 v25, v25
    v_exp_f32 v26, v26
    v_smfmac_f32_32x32x32_bf16 v[56:71], v[96:99], v[16:23], v48
    v_exp_f32 v27, v27
    v_exp_f32 v28, v28
    v_exp_f32 v29, v29
    v_exp_f32 v30, v30
    v_exp_f32 v31, v31
    v_exp_f32 v32, v32
    v_exp_f32 v33, v33
    v_smfmac_f32_32x32x32_bf16 v[56:71], v[100:103], v[24:31], v48
    s_waitcnt lgkmcnt(0)
    v_exp_f32 v34, v34
    v_exp_f32 v35, v35
    v_exp_f32 v36, v36
    v_mfma_f32_32x32x16_bf16 v[16:31], v[92:95], v[8:11], 0
    s_setprio 0
    v_exp_f32 v37, v37
    v_exp_f32 v38, v38
    v_exp_f32 v39, v39
    v_exp_f32 v40, v40
    v_exp_f32 v41, v41
    v_exp_f32 v42, v42
    v_smfmac_f32_32x32x32_bf16 v[72:87], v[96:99], v[32:39], v48
    s_waitcnt vmcnt(0)
    s_barrier
    v_cmp_ne_u32 vcc, s66, v228
    s_add_u32 m0, s47, 133120
    s_nop 0
    s_cbranch_vccnz KF_EP2
KF_EP2R:
    buffer_load_dwordx4 v6, s[20:23], s64 offen sc1 lds
    buffer_load_dword v226, v246, s[20:23], s65 offen sc1
    v_exp_f32 v43, v43
    v_exp_f32 v44, v44
    v_exp_f32 v45, v45
    v_exp_f32 v46, v46
    v_exp_f32 v47, v47
    v_exp_f32 v16, v16
    v_exp_f32 v17, v17
    v_smfmac_f32_32x32x32_bf16 v[72:87], v[100:103], v[40:47], v48
    s_setprio 3
    v_exp_f32 v18, v18
    v_exp_f32 v19, v19
    v_exp_f32 v20, v20
    v_mfma_f32_32x32x16_bf16 v[32:47], v[92:95], v[12:15], 0
    ds_read_b128 v[88:91], v2 offset:16384
    ds_read_b128 v[96:99], v3 offset:16896
    ds_read_b128 v[100:103], v4 offset:17408
    v_exp_f32 v21, v21
    v_exp_f32 v22, v22
    v_exp_f32 v23, v23
    v_exp_f32 v24, v24
    v_exp_f32 v25, v25
    v_exp_f32 v26, v26
    v_smfmac_f32_32x32x32_bf16 v[56:71], v[104:107], v[16:23], v48
    s_mov_b32 s13, s47
    s_mov_b32 s14, 32768
    v_exp_f32 v27, v27
    v_exp_f32 v28, v28
    v_exp_f32 v29, v29
    v_exp_f32 v30, v30
    v_exp_f32 v31, v31
    v_exp_f32 v32, v32
    v_exp_f32 v33, v33
    v_smfmac_f32_32x32x32_bf16 v[56:71], v[108:111], v[24:31], v48
    s_waitcnt lgkmcnt(0)
    v_exp_f32 v34, v34
    v_exp_f32 v35, v35
    v_exp_f32 v36, v36
    v_mfma_f32_32x32x16_bf16 v[16:31], v[88:91], v[8:11], 0
    s_mov_b32 s15, 33792
    v_exp_f32 v37, v37
    v_exp_f32 v38, v38
    v_exp_f32 v39, v39
    v_exp_f32 v40, v40
    v_exp_f32 v41, v41
    v_exp_f32 v42, v42
    v_smfmac_f32_32x32x32_bf16 v[72:87], v[104:107], v[32:39], v48
    v_exp_f32 v43, v43
    v_exp_f32 v44, v44
    v_exp_f32 v45, v45
    v_exp_f32 v46, v46
    v_exp_f32 v47, v47
    s_cmp_eq_u32 s39, 0
    s_cselect_b32 s39, 0, 100
    s_mov_b32 s43, 4
.p2align 6
KF_LC:
    v_exp_f32 v16, v16
    v_exp_f32 v17, v17
    v_smfmac_f32_32x32x32_bf16 v[72:87], v[108:111], v[40:47], v48
    s_mov_b32 m0, s13
    v_exp_f32 v18, v18
    v_exp_f32 v19, v19
    v_exp_f32 v20, v20
    v_mfma_f32_32x32x16_bf16 v[32:47], v[88:91], v[12:15], 0
    ds_read_b128 v[92:95], v2 offset:17408
    ds_read_b128 v[104:107], v3 offset:17952
    ds_read_b128 v[108:111], v4 offset:18464
    v_exp_f32 v21, v21
    v_exp_f32 v22, v22
    v_exp_f32 v23, v23
    v_exp_f32 v24, v24
    v_exp_f32 v25, v25
    v_exp_f32 v26, v26
    v_smfmac_f32_32x32x32_bf16 v[56:71], v[96:99], v[16:23], v48
    buffer_load_dwordx4 v5, s[4:7], s12 offen lds
    v_exp_f32 v27, v27
    v_exp_f32 v28, v28
    v_exp_f32 v29, v29
    v_exp_f32 v30, v30
    v_exp_f32 v31, v31
    v_exp_f32 v32, v32
    v_exp_f32 v33, v33
    v_smfmac_f32_32x32x32_bf16 v[56:71], v[100:103], v[24:31], v48
    s_waitcnt lgkmcnt(0)
    v_exp_f32 v34, v34
    v_exp_f32 v35, v35
    v_exp_f32 v36, v36
    v_mfma_f32_32x32x16_bf16 v[16:31], v[92:95], v[8:11], 0
    s_setprio 2
    v_exp_f32 v37, v37
    v_exp_f32 v38, v38
    v_exp_f32 v39, v39
    v_exp_f32 v40, v40
    v_exp_f32 v41, v41
    v_exp_f32 v42, v42
    v_smfmac_f32_32x32x32_bf16 v[72:87], v[96:99], v[32:39], v48
    s_add_u32 s12, s12, 0x10000
    s_add_u32 m0, s13, 8192
    v_exp_f32 v43, v43
    v_exp_f32 v44, v44
    v_exp_f32 v45, v45
    v_exp_f32 v46, v46
    v_exp_f32 v47, v47
    v_exp_f32 v16, v16
    v_exp_f32 v17, v17
    v_smfmac_f32_32x32x32_bf16 v[72:87], v[100:103], v[40:47], v48
    s_and_b32 s12, s12, 0x7ffff
    v_exp_f32 v18, v18
    v_exp_f32 v19, v19
    v_exp_f32 v20, v20
    v_mfma_f32_32x32x16_bf16 v[32:47], v[92:95], v[12:15], 0
    ds_read_b128 v[88:91], v2 offset:18432
    ds_read_b128 v[96:99], v3 offset:19008
    ds_read_b128 v[100:103], v4 offset:19520
    v_exp_f32 v21, v21
    v_exp_f32 v22, v22
    v_exp_f32 v23, v23
    v_exp_f32 v24, v24
    v_exp_f32 v25, v25
    v_exp_f32 v26, v26
    v_smfmac_f32_32x32x32_bf16 v[56:71], v[104:107], v[16:23], v48
    buffer_load_dwordx4 v5, s[4:7], s12 offen lds
    v_exp_f32 v27, v27
    v_exp_f32 v28, v28
    v_exp_f32 v29, v29
    v_exp_f32 v30, v30
    v_exp_f32 v31, v31
    v_exp_f32 v32, v32
    v_exp_f32 v33, v33
    v_smfmac_f32_32x32x32_bf16 v[56:71], v[108:111], v[24:31], v48
    s_waitcnt lgkmcnt(0)
    v_exp_f32 v34, v34
    v_exp_f32 v35, v35
    v_exp_f32 v36, v36
    v_mfma_f32_32x32x16_bf16 v[16:31], v[88:91], v[8:11], 0
    s_setprio 1
    v_exp_f32 v37, v37
    v_exp_f32 v38, v38
    v_exp_f32 v39, v39
    v_exp_f32 v40, v40
    v_exp_f32 v41, v41
    v_exp_f32 v42, v42
    v_smfmac_f32_32x32x32_bf16 v[72:87], v[104:107], v[32:39], v48
    s_add_u32 s12, s12, 0x10000
    s_cmp_eq_u32 s43, 2
    v_exp_f32 v43, v43
    v_exp_f32 v44, v44
    v_exp_f32 v45, v45
    v_exp_f32 v46, v46
    v_exp_f32 v47, v47
    v_exp_f32 v16, v16
    v_exp_f32 v17, v17
    v_smfmac_f32_32x32x32_bf16 v[72:87], v[108:111], v[40:47], v48
    s_cselect_b32 s53, s15, s14
    v_exp_f32 v18, v18
    v_exp_f32 v19, v19
    v_exp_f32 v20, v20
    v_mfma_f32_32x32x16_bf16 v[32:47], v[88:91], v[12:15], 0
    ds_read_b128 v[92:95], v2 offset:19456
    ds_read_b128 v[104:107], v3 offset:20064
    ds_read_b128 v[108:111], v4 offset:20576
    v_exp_f32 v21, v21
    v_exp_f32 v22, v22
    v_exp_f32 v23, v23
    v_exp_f32 v24, v24
    v_exp_f32 v25, v25
    v_exp_f32 v26, v26
    v_smfmac_f32_32x32x32_bf16 v[56:71], v[96:99], v[16:23], v48
    v_exp_f32 v27, v27
    v_exp_f32 v28, v28
    v_exp_f32 v29, v29
    v_exp_f32 v30, v30
    v_exp_f32 v31, v31
    v_exp_f32 v32, v32
    v_exp_f32 v33, v33
    v_smfmac_f32_32x32x32_bf16 v[56:71], v[100:103], v[24:31], v48
    s_waitcnt lgkmcnt(0)
    v_exp_f32 v34, v34
    v_exp_f32 v35, v35
    v_exp_f32 v36, v36
    v_mfma_f32_32x32x16_bf16 v[16:31], v[92:95], v[8:11], 0
    s_setprio 0
    v_exp_f32 v37, v37
    v_exp_f32 v38, v38
    v_exp_f32 v39, v39
    v_exp_f32 v40, v40
    v_exp_f32 v41, v41
    v_exp_f32 v42, v42
    v_smfmac_f32_32x32x32_bf16 v[72:87], v[96:99], v[32:39], v48
    s_and_b32 s12, s12, 0x7ffff
    s_add_u32 s13, s13, s53
    v_exp_f32 v43, v43
    v_exp_f32 v44, v44
    v_exp_f32 v45, v45
    v_exp_f32 v46, v46
    v_exp_f32 v47, v47
    v_exp_f32 v16, v16
    v_exp_f32 v17, v17
    v_smfmac_f32_32x32x32_bf16 v[72:87], v[100:103], v[40:47], v48
    s_setprio 3
    v_exp_f32 v18, v18
    v_exp_f32 v19, v19
    v_exp_f32 v20, v20
    v_mfma_f32_32x32x16_bf16 v[32:47], v[92:95], v[12:15], 0
    ds_read_b128 v[88:91], v2 offset:20480
    ds_read_b128 v[96:99], v3 offset:21120
    ds_read_b128 v[100:103], v4 offset:21632
    v_exp_f32 v21, v21
    v_exp_f32 v22, v22
    v_exp_f32 v23, v23
    v_exp_f32 v24, v24
    v_exp_f32 v25, v25
    v_exp_f32 v26, v26
    v_smfmac_f32_32x32x32_bf16 v[56:71], v[104:107], v[16:23], v48
    s_cmp_eq_u32 s39, 0
    s_cbranch_scc1 KF_WB
KF_WBR:
    s_add_u32 s39, s39, 1
    v_exp_f32 v27, v27
    v_exp_f32 v28, v28
    v_exp_f32 v29, v29
    v_exp_f32 v30, v30
    v_exp_f32 v31, v31
    v_exp_f32 v32, v32
    v_exp_f32 v33, v33
    v_smfmac_f32_32x32x32_bf16 v[56:71], v[108:111], v[24:31], v48
    s_waitcnt lgkmcnt(0)
    v_exp_f32 v34, v34
    v_exp_f32 v35, v35
    v_exp_f32 v36, v36
    v_mfma_f32_32x32x16_bf16 v[16:31], v[88:91], v[8:11], 0
    s_sub_u32 s43, s43, 1
    v_exp_f32 v37, v37
    v_exp_f32 v38, v38
    v_exp_f32 v39, v39
    v_exp_f32 v40, v40
    v_exp_f32 v41, v41
    v_exp_f32 v42, v42
    v_smfmac_f32_32x32x32_bf16 v[72:87], v[104:107], v[32:39], v48
    s_cmp_lg_u32 s43, 0
    v_exp_f32 v43, v43
    v_exp_f32 v44, v44
    v_exp_f32 v45, v45
    v_exp_f32 v46, v46
    v_exp_f32 v47, v47
    v_add_u32 v2, 4096, v2
    v_add_u32 v3, 4224, v3
    v_add_u32 v4, 4224, v4
    s_cbranch_scc1 KF_LC
    s_add_u32 s30, s30, 28672
    s_add_u32 s31, s31, 28672
    s_add_u32 s32, s32, 28672
    s_add_u32 s38, s38, 29568
KF_DONE:
    s_nop 1
    v_smfmac_f32_32x32x32_bf16 v[72:87], v[108:111], v[40:47], v48
    s_add_u32 s33, s28, s37
    s_lshl_b32 s50, s33, 7
    s_lshl_b32 s34, s25, 2
    s_add_u32 s50, s50, s34
    s_add_u32 s50, s50, 18219008
    s_lshl_b32 s33, s33, 15
    s_lshl_b32 s34, s25, 10
    s_add_u32 s33, s33, s34
    s_add_u32 s33, s33, 6291456
    s_setprio 0
    s_mov_b32 s56, 0x7b800000
    s_mov_b32 s57, 0x71800000
    s_mov_b32 s58, 0x0d800000
    s_cmp_eq_u32 s37, 0
    s_cbranch_scc1 KF_X0
    ds_write_b128 v237, v[56:59]
    ds_write_b128 v237, v[60:63] offset:1024
    ds_write_b32 v239, v64 offset:2048
    v_mov_b32 v16, v72
    v_mov_b32 v17, v73
    v_mov_b32 v18, v74
    v_mov_b32 v19, v75
    v_mov_b32 v20, v76
    v_mov_b32 v21, v77
    v_mov_b32 v22, v78
    v_mov_b32 v23, v79
    v_mov_b32 v24, v80
    s_branch KF_X1
KF_X0:
    ds_write_b128 v237, v[72:75]
    ds_write_b128 v237, v[76:79] offset:1024
    ds_write_b32 v239, v80 offset:2048
    v_mov_b32 v16, v56
    v_mov_b32 v17, v57
    v_mov_b32 v18, v58
    v_mov_b32 v19, v59
    v_mov_b32 v20, v60
    v_mov_b32 v21, v61
    v_mov_b32 v22, v62
    v_mov_b32 v23, v63
    v_mov_b32 v24, v64
KF_X1:
    s_waitcnt vmcnt(0) lgkmcnt(0)
    s_barrier
    ds_read_b32 v40, v240 offset:2048
    ds_read_b128 v[32:35], v238
    ds_read_b128 v[36:39], v238 offset:1024
    s_waitcnt lgkmcnt(2)
    v_add_f32 v24, v24, v40
    v_rcp_f32 v180, v24
    s_waitcnt lgkmcnt(0)
    v_add_f32 v16, v16, v32
    v_add_f32 v17, v17, v33
    v_add_f32 v18, v18, v34
    v_add_f32 v19, v19, v35
    v_add_f32 v20, v20, v36
    v_add_f32 v21, v21, v37
    v_add_f32 v22, v22, v38
    v_add_f32 v23, v23, v39
    v_mul_f32 v32, v16, v180
    v_mul_f32 v33, v17, v180
    v_mul_f32 v34, v18, v180
    v_mul_f32 v35, v19, v180
    v_mul_f32 v36, v20, v180
    v_mul_f32 v37, v21, v180
    v_mul_f32 v38, v22, v180
    v_mul_f32 v39, v23, v180
    v_cvt_pk_bf16_f32 v48, v32, v33
    v_cvt_pk_bf16_f32 v49, v34, v35
    v_cvt_pk_bf16_f32 v50, v36, v37
    v_cvt_pk_bf16_f32 v51, v38, v39
    buffer_store_dwordx4 v[48:51], v7, s[20:23], s33 offen sc1
    s_cmp_lg_u32 s46, 0
    s_cbranch_scc1 KF_REWO
    v_add_f32 v176, abs(v16), abs(v17)
    v_add_f32 v177, abs(v18), abs(v19)
    v_add_f32 v178, abs(v20), abs(v21)
    v_add_f32 v179, abs(v22), abs(v23)
    v_add_f32 v176, v176, v177
    v_add_f32 v178, v178, v179
    v_add_f32 v176, v176, v178
    v_cmp_gt_f32 s[52:53], s56, v176
    v_cmp_gt_f32 s[54:55], s57, v24
    v_cmp_lt_f32 s[64:65], s58, v24
    v_mov_b32 v177, 162816
    v_mov_b32 v178, 1
    s_and_b64 s[52:53], s[52:53], s[54:55]
    s_and_b64 s[52:53], s[52:53], s[64:65]
    s_cmp_eq_u64 s[52:53], -1
    s_cbranch_scc1 KF_OK
    ds_write_b32 v177, v178
KF_OK:
    s_waitcnt lgkmcnt(0)
    s_barrier
    ds_read_b32 v178, v177
    s_waitcnt lgkmcnt(0)
    v_readfirstlane_b32 s53, v178
    s_nop 0
    s_cmp_eq_u32 s53, 0
    s_cbranch_scc0 KF_FALL
KF_PC3:
    s_waitcnt vmcnt(0)
    v_mov_b32 v28, 0
    v_mov_b32 v29, s66
    s_mov_b64 exec, 1
    buffer_store_dword v29, v28, s[20:23], s50 offen sc0 sc1
    s_mov_b64 exec, -1
    s_and_b32 s53, s24, 1
    s_lshr_b32 s55, s24, 1
    s_lshl_b32 s41, s25, 16
    s_lshl_b32 s42, s53, 15
    s_add_u32 s41, s41, s42
    s_lshl_b32 s42, s55, 5
    s_add_u32 s41, s41, s42
    s_lshl_b32 s42, s26, 7
    s_add_u32 s41, s41, s42
    s_add_u32 s42, s41, 16384
    s_lshl_b32 s51, s25, 8
    s_add_u32 s51, s51, 18219008
    s_lshl_b32 s68, s25, 16
    s_lshl_b32 s54, s37, 15
    s_add_u32 s68, s68, s54
    s_lshl_b32 s54, s36, 10
    s_add_u32 s68, s68, s54
    s_add_u32 s68, s68, 6291456
    s_mov_b32 s40, 0xffff0000
    v_add_u32 v24, 65536, v232
    ds_read_b64_tr_b16 v[56:57], v232 offset:0
    ds_read_b64_tr_b16 v[58:59], v232 offset:1024
    ds_read_b64_tr_b16 v[60:61], v232 offset:4096
    ds_read_b64_tr_b16 v[62:63], v232 offset:5120
    ds_read_b64_tr_b16 v[64:65], v232 offset:8192
    ds_read_b64_tr_b16 v[66:67], v232 offset:9216
    ds_read_b64_tr_b16 v[68:69], v232 offset:12288
    ds_read_b64_tr_b16 v[70:71], v232 offset:13312
    ds_read_b64_tr_b16 v[72:73], v232 offset:32768
    ds_read_b64_tr_b16 v[74:75], v232 offset:33792
    ds_read_b64_tr_b16 v[76:77], v232 offset:36864
    ds_read_b64_tr_b16 v[78:79], v232 offset:37888
    ds_read_b64_tr_b16 v[80:81], v232 offset:40960
    ds_read_b64_tr_b16 v[82:83], v232 offset:41984
    ds_read_b64_tr_b16 v[84:85], v232 offset:45056
    ds_read_b64_tr_b16 v[86:87], v232 offset:46080
    ds_read_b64_tr_b16 v[88:89], v24 offset:0
    ds_read_b64_tr_b16 v[90:91], v24 offset:1024
    ds_read_b64_tr_b16 v[92:93], v24 offset:4096
    ds_read_b64_tr_b16 v[94:95], v24 offset:5120
    ds_read_b64_tr_b16 v[96:97], v24 offset:8192
    ds_read_b64_tr_b16 v[98:99], v24 offset:9216
    ds_read_b64_tr_b16 v[100:101], v24 offset:12288
    ds_read_b64_tr_b16 v[102:103], v24 offset:13312
    ds_read_b64_tr_b16 v[104:105], v24 offset:33792
    ds_read_b64_tr_b16 v[106:107], v24 offset:34816
    ds_read_b64_tr_b16 v[108:109], v24 offset:37888
    ds_read_b64_tr_b16 v[110:111], v24 offset:38912
    ds_read_b64_tr_b16 v[112:113], v24 offset:41984
    ds_read_b64_tr_b16 v[114:115], v24 offset:43008
    ds_read_b64_tr_b16 v[116:117], v24 offset:46080
    ds_read_b64_tr_b16 v[118:119], v24 offset:47104
    ds_read_b64_tr_b16 v[20:21], v233
    ds_read_b64_tr_b16 v[22:23], v233 offset:32
    v_and_b32 v27, 60, v229
    ds_bpermute_b32 v40, v27, v226
    v_add_u32 v27, 64, v27
    ds_bpermute_b32 v41, v27, v226
    s_waitcnt lgkmcnt(0)
    v_sub_f32 v42, 1.0, v40
    v_sub_f32 v43, 1.0, v41
    v_cvt_pk_bf16_f32 v42, v42, v42
    v_cvt_pk_bf16_f32 v43, v43, v43
    v_and_b32 v42, s40, v42
    v_and_b32 v43, s40, v43
    v_lshlrev_b32 v10, 16, v20
    v_and_b32 v11, s40, v20
    v_lshlrev_b32 v12, 16, v21
    v_and_b32 v13, s40, v21
    v_lshlrev_b32 v14, 16, v22
    v_and_b32 v15, s40, v22
    v_lshlrev_b32 v16, 16, v23
    v_and_b32 v17, s40, v23
    v_mul_f32 v10, v42, v10
    v_mul_f32 v11, v42, v11
    v_mul_f32 v12, v42, v12
    v_mul_f32 v13, v42, v13
    v_mul_f32 v14, v43, v14
    v_mul_f32 v15, v43, v15
    v_mul_f32 v16, v43, v16
    v_mul_f32 v17, v43, v17
    s_add_u32 s52, s26, 0
    s_and_b32 s52, s52, 7
    s_lshl_b32 s52, s52, 12
    s_add_u32 s52, s52, s68
    s_add_u32 s53, s26, 1
    s_and_b32 s53, s53, 7
    s_lshl_b32 s53, s53, 12
    s_add_u32 s53, s53, s68
    s_add_u32 s54, s26, 2
    s_and_b32 s54, s54, 7
    s_lshl_b32 s54, s54, 12
    s_add_u32 s54, s54, s68
    s_add_u32 s55, s26, 3
    s_and_b32 s55, s55, 7
    s_lshl_b32 s55, s55, 12
    s_add_u32 s55, s55, s68
    s_add_u32 s56, s26, 4
    s_and_b32 s56, s56, 7
    s_lshl_b32 s56, s56, 12
    s_add_u32 s56, s56, s68
    s_add_u32 s57, s26, 5
    s_and_b32 s57, s57, 7
    s_lshl_b32 s57, s57, 12
    s_add_u32 s57, s57, s68
    s_add_u32 s58, s26, 6
    s_and_b32 s58, s58, 7
    s_lshl_b32 s58, s58, 12
    s_add_u32 s58, s58, s68
    s_add_u32 s59, s26, 7
    s_and_b32 s59, s59, 7
    s_lshl_b32 s59, s59, 12
    s_add_u32 s59, s59, s68
    s_cmp_lg_u32 s24, 0
    s_cbranch_scc1 KF_OW
    s_mov_b32 s67, 400000
PL4:
    buffer_load_dword v31, v242, s[20:23], s51 offen sc1
    s_sub_u32 s67, s67, 1
    s_waitcnt vmcnt(0)
    v_cmp_ne_u32 vcc, s66, v31
    s_cmp_eq_u32 s67, 0
    s_cbranch_scc1 PL4_X
    s_cbranch_vccz PL4_X
    s_sleep 2
    s_branch PL4
PL4_X:
KF_OW:
    s_barrier
    s_add_u32 m0, s47, 16384
    s_nop 0
    buffer_load_dwordx4 v7, s[20:23], s52 offen sc1 lds
    s_add_u32 m0, s47, 24576
    s_nop 0
    buffer_load_dwordx4 v7, s[20:23], s53 offen sc1 lds
    s_barrier
    s_add_u32 m0, s47, 49152
    s_nop 0
    buffer_load_dwordx4 v7, s[20:23], s54 offen sc1 lds
    s_add_u32 m0, s47, 57344
    s_nop 0
    buffer_load_dwordx4 v7, s[20:23], s55 offen sc1 lds
    s_add_u32 m0, s47, 82432
    s_nop 0
    buffer_load_dwordx4 v7, s[20:23], s56 offen sc1 lds
    s_barrier
    s_add_u32 m0, s47, 90624
    s_nop 0
    buffer_load_dwordx4 v7, s[20:23], s57 offen sc1 lds
    s_add_u32 m0, s47, 116224
    s_nop 0
    buffer_load_dwordx4 v7, s[20:23], s58 offen sc1 lds
    s_add_u32 m0, s47, 124416
    s_nop 0
    buffer_load_dwordx4 v7, s[20:23], s59 offen sc1 lds
    s_waitcnt vmcnt(6)
    s_barrier
    ds_read_b128 v[160:163], v234 offset:16384
    ds_read_b128 v[164:167], v234 offset:16640
    ds_read_b128 v[168:171], v234 offset:18432
    ds_read_b128 v[172:175], v234 offset:18688
    ds_read_b128 v[176:179], v234 offset:24576
    ds_read_b128 v[180:183], v234 offset:24832
    ds_read_b128 v[184:187], v234 offset:26624
    ds_read_b128 v[188:191], v234 offset:26880
    s_waitcnt lgkmcnt(7)
    v_mfma_f32_16x16x32_bf16 v[32:35], v[56:59], v[160:163], 0
    s_waitcnt lgkmcnt(6)
    v_mfma_f32_16x16x32_bf16 v[36:39], v[56:59], v[164:167], 0
    s_waitcnt lgkmcnt(5)
    v_mfma_f32_16x16x32_bf16 v[32:35], v[60:63], v[168:171], v[32:35]
    s_waitcnt lgkmcnt(4)
    v_mfma_f32_16x16x32_bf16 v[36:39], v[60:63], v[172:175], v[36:39]
    s_waitcnt lgkmcnt(3)
    v_mfma_f32_16x16x32_bf16 v[32:35], v[64:67], v[176:179], v[32:35]
    s_waitcnt lgkmcnt(2)
    v_mfma_f32_16x16x32_bf16 v[36:39], v[64:67], v[180:183], v[36:39]
    s_waitcnt lgkmcnt(1)
    v_mfma_f32_16x16x32_bf16 v[32:35], v[68:71], v[184:187], v[32:35]
    s_waitcnt lgkmcnt(0)
    v_mfma_f32_16x16x32_bf16 v[36:39], v[68:71], v[188:191], v[36:39]
    s_waitcnt vmcnt(4)
    s_barrier
    ds_read_b128 v[192:195], v234 offset:49152
    ds_read_b128 v[196:199], v234 offset:49408
    ds_read_b128 v[200:203], v234 offset:51200
    ds_read_b128 v[204:207], v234 offset:51456
    ds_read_b128 v[208:211], v234 offset:57344
    ds_read_b128 v[212:215], v234 offset:57600
    ds_read_b128 v[216:219], v234 offset:59392
    ds_read_b128 v[220:223], v234 offset:59648
    s_waitcnt lgkmcnt(7)
    v_mfma_f32_16x16x32_bf16 v[32:35], v[72:75], v[192:195], v[32:35]
    s_waitcnt lgkmcnt(6)
    v_mfma_f32_16x16x32_bf16 v[36:39], v[72:75], v[196:199], v[36:39]
    s_waitcnt lgkmcnt(5)
    v_mfma_f32_16x16x32_bf16 v[32:35], v[76:79], v[200:203], v[32:35]
    s_waitcnt lgkmcnt(4)
    v_mfma_f32_16x16x32_bf16 v[36:39], v[76:79], v[204:207], v[36:39]
    s_waitcnt lgkmcnt(3)
    v_mfma_f32_16x16x32_bf16 v[32:35], v[80:83], v[208:211], v[32:35]
    s_waitcnt lgkmcnt(2)
    v_mfma_f32_16x16x32_bf16 v[36:39], v[80:83], v[212:215], v[36:39]
    s_waitcnt lgkmcnt(1)
    v_mfma_f32_16x16x32_bf16 v[32:35], v[84:87], v[216:219], v[32:35]
    s_waitcnt lgkmcnt(0)
    v_mfma_f32_16x16x32_bf16 v[36:39], v[84:87], v[220:223], v[36:39]
    s_waitcnt vmcnt(2)
    s_barrier
    ds_read_b128 v[160:163], v235 offset:0
    ds_read_b128 v[164:167], v235 offset:256
    ds_read_b128 v[168:171], v235 offset:2048
    ds_read_b128 v[172:175], v235 offset:2304
    ds_read_b128 v[176:179], v235 offset:8192
    ds_read_b128 v[180:183], v235 offset:8448
    ds_read_b128 v[184:187], v235 offset:10240
    ds_read_b128 v[188:191], v235 offset:10496
    s_waitcnt lgkmcnt(7)
    v_mfma_f32_16x16x32_bf16 v[32:35], v[88:91], v[160:163], v[32:35]
    s_waitcnt lgkmcnt(6)
    v_mfma_f32_16x16x32_bf16 v[36:39], v[88:91], v[164:167], v[36:39]
    s_waitcnt lgkmcnt(5)
    v_mfma_f32_16x16x32_bf16 v[32:35], v[92:95], v[168:171], v[32:35]
    s_waitcnt lgkmcnt(4)
    v_mfma_f32_16x16x32_bf16 v[36:39], v[92:95], v[172:175], v[36:39]
    s_waitcnt lgkmcnt(3)
    v_mfma_f32_16x16x32_bf16 v[32:35], v[96:99], v[176:179], v[32:35]
    s_waitcnt lgkmcnt(2)
    v_mfma_f32_16x16x32_bf16 v[36:39], v[96:99], v[180:183], v[36:39]
    s_waitcnt lgkmcnt(1)
    v_mfma_f32_16x16x32_bf16 v[32:35], v[100:103], v[184:187], v[32:35]
    s_waitcnt lgkmcnt(0)
    v_mfma_f32_16x16x32_bf16 v[36:39], v[100:103], v[188:191], v[36:39]
    s_waitcnt vmcnt(0)
    s_barrier
    ds_read_b128 v[192:195], v235 offset:33792
    ds_read_b128 v[196:199], v235 offset:34048
    ds_read_b128 v[200:203], v235 offset:35840
    ds_read_b128 v[204:207], v235 offset:36096
    ds_read_b128 v[208:211], v235 offset:41984
    ds_read_b128 v[212:215], v235 offset:42240
    ds_read_b128 v[216:219], v235 offset:44032
    ds_read_b128 v[220:223], v235 offset:44288
    s_waitcnt lgkmcnt(7)
    v_mfma_f32_16x16x32_bf16 v[32:35], v[104:107], v[192:195], v[32:35]
    s_waitcnt lgkmcnt(6)
    v_mfma_f32_16x16x32_bf16 v[36:39], v[104:107], v[196:199], v[36:39]
    s_waitcnt lgkmcnt(5)
    v_mfma_f32_16x16x32_bf16 v[32:35], v[108:111], v[200:203], v[32:35]
    s_waitcnt lgkmcnt(4)
    v_mfma_f32_16x16x32_bf16 v[36:39], v[108:111], v[204:207], v[36:39]
    s_waitcnt lgkmcnt(3)
    v_mfma_f32_16x16x32_bf16 v[32:35], v[112:115], v[208:211], v[32:35]
    s_waitcnt lgkmcnt(2)
    v_mfma_f32_16x16x32_bf16 v[36:39], v[112:115], v[212:215], v[36:39]
    s_waitcnt lgkmcnt(1)
    v_mfma_f32_16x16x32_bf16 v[32:35], v[116:119], v[216:219], v[32:35]
    s_waitcnt lgkmcnt(0)
    v_mfma_f32_16x16x32_bf16 v[36:39], v[116:119], v[220:223], v[36:39]
    s_nop 5
    v_fma_f32 v10, v40, v32, v10
    v_fma_f32 v11, v40, v33, v11
    v_fma_f32 v12, v40, v34, v12
    v_fma_f32 v13, v40, v35, v13
    v_fma_f32 v14, v41, v36, v14
    v_fma_f32 v15, v41, v37, v15
    v_fma_f32 v16, v41, v38, v16
    v_fma_f32 v17, v41, v39, v17
    v_cvt_pk_bf16_f32 v20, v10, v11
    v_cvt_pk_bf16_f32 v21, v12, v13
    buffer_store_dwordx2 v[20:21], v236, s[8:11], s41 offen
    v_cvt_pk_bf16_f32 v22, v14, v15
    v_cvt_pk_bf16_f32 v23, v16, v17
    buffer_store_dwordx2 v[22:23], v236, s[8:11], s42 offen
    s_endpgm
KF_CF:
    ds_read_b128 v[200:203], v216 offset:0
    ds_read_b128 v[204:207], v216 offset:1056
    ds_read_b128 v[208:211], v216 offset:2112
    ds_read_b128 v[212:215], v216 offset:3168
    s_waitcnt lgkmcnt(0)
    v_add_f32 v184, v184, v200
    v_add_f32 v185, v185, v201
    v_add_f32 v186, v186, v202
    v_add_f32 v187, v187, v203
    v_add_f32 v188, v188, v204
    v_add_f32 v189, v189, v205
    v_add_f32 v190, v190, v206
    v_add_f32 v191, v191, v207
    v_add_f32 v192, v192, v208
    v_add_f32 v193, v193, v209
    v_add_f32 v194, v194, v210
    v_add_f32 v195, v195, v211
    v_add_f32 v196, v196, v212
    v_add_f32 v197, v197, v213
    v_add_f32 v198, v198, v214
    v_add_f32 v199, v199, v215
    v_cvt_pk_bf16_f32 v184, v184, v185
    v_cvt_pk_bf16_f32 v185, v186, v187
    v_cvt_pk_bf16_f32 v186, v188, v189
    v_cvt_pk_bf16_f32 v187, v190, v191
    v_cvt_pk_bf16_f32 v188, v192, v193
    v_cvt_pk_bf16_f32 v189, v194, v195
    v_cvt_pk_bf16_f32 v190, v196, v197
    v_cvt_pk_bf16_f32 v191, v198, v199
    buffer_store_dwordx2 v[184:185], v217, s[20:23], s70 offen offset:0 sc1
    buffer_store_dwordx2 v[186:187], v217, s[20:23], s70 offen offset:512 sc1
    buffer_store_dwordx2 v[188:189], v217, s[20:23], s70 offen offset:1024 sc1
    buffer_store_dwordx2 v[190:191], v217, s[20:23], s70 offen offset:1536 sc1
    s_branch KF_CFR
KF_BF:
    v_mov_b32 v176, 0
    v_mov_b32 v177, s66
    s_mov_b64 exec, 1
    buffer_store_dword v177, v176, s[20:23], s44 offen sc0 sc1
    buffer_store_dword v177, v176, s[20:23], s45 offen sc0 sc1
    s_mov_b64 exec, -1
    s_branch KF_BFR
KF_EP2:
    s_mov_b32 s67, 400000
PL3:
    buffer_load_dword v228, v227, s[20:23], s49 offen sc1
    s_sub_u32 s67, s67, 1
    s_waitcnt vmcnt(0)
    v_cmp_ne_u32 vcc, s66, v228
    s_cmp_eq_u32 s67, 0
    s_cbranch_scc1 PL3_X
    s_cbranch_vccz PL3_X
    s_sleep 2
    s_branch PL3
PL3_X:
    s_branch KF_EP2R
KF_WB:
    buffer_wbl2 sc1
    s_branch KF_WBR
KF_FALL:
    s_mov_b32 s46, 1
    s_sub_u32 s30, s30, 32768
    s_sub_u32 s31, s31, 32768
    s_sub_u32 s32, s32, 32768
    s_sub_u32 s38, s38, 33792
    s_mov_b32 m0, s30
    s_add_u32 s30, s30, 4096
    buffer_load_dwordx4 v7, s[20:23], s31 offen sc1 lds
    s_mov_b32 m0, s38
    s_add_u32 s38, s38, 4224
    buffer_load_dwordx4 v7, s[20:23], s32 offen sc1 lds
    s_add_u32 s31, s31, 4096
    s_add_u32 s32, s32, 4096
    s_mov_b32 m0, s30
    s_add_u32 s30, s30, 4096
    buffer_load_dwordx4 v7, s[20:23], s31 offen sc1 lds
    s_mov_b32 m0, s38
    s_add_u32 s38, s38, 4224
    buffer_load_dwordx4 v7, s[20:23], s32 offen sc1 lds
    s_add_u32 s31, s31, 4096
    s_add_u32 s32, s32, 4096
    s_mov_b32 m0, s30
    s_add_u32 s30, s30, 4096
    buffer_load_dwordx4 v7, s[20:23], s31 offen sc1 lds
    s_mov_b32 m0, s38
    s_add_u32 s38, s38, 4224
    buffer_load_dwordx4 v7, s[20:23], s32 offen sc1 lds
    s_add_u32 s31, s31, 4096
    s_add_u32 s32, s32, 4096
    s_mov_b32 m0, s30
    s_add_u32 s30, s30, 4096
    buffer_load_dwordx4 v7, s[20:23], s31 offen sc1 lds
    s_mov_b32 m0, s38
    s_add_u32 s38, s38, 4224
    buffer_load_dwordx4 v7, s[20:23], s32 offen sc1 lds
    s_add_u32 s31, s31, 4096
    s_add_u32 s32, s32, 4096
    s_mov_b32 m0, s30
    s_add_u32 s30, s30, 4096
    buffer_load_dwordx4 v7, s[20:23], s31 offen sc1 lds
    s_mov_b32 m0, s38
    s_add_u32 s38, s38, 4224
    buffer_load_dwordx4 v7, s[20:23], s32 offen sc1 lds
    s_add_u32 s31, s31, 4096
    s_add_u32 s32, s32, 4096
    s_mov_b32 m0, s30
    s_add_u32 s30, s30, 4096
    buffer_load_dwordx4 v7, s[20:23], s31 offen sc1 lds
    s_mov_b32 m0, s38
    s_add_u32 s38, s38, 4224
    buffer_load_dwordx4 v7, s[20:23], s32 offen sc1 lds
    s_add_u32 s31, s31, 4096
    s_add_u32 s32, s32, 4096
    s_mov_b32 m0, s30
    s_add_u32 s30, s30, 4096
    buffer_load_dwordx4 v7, s[20:23], s31 offen sc1 lds
    s_mov_b32 m0, s38
    s_add_u32 s38, s38, 4224
    buffer_load_dwordx4 v7, s[20:23], s32 offen sc1 lds
    s_add_u32 s31, s31, 4096
    s_add_u32 s32, s32, 4096
    s_mov_b32 m0, s30
    s_add_u32 s30, s30, 4096
    buffer_load_dwordx4 v7, s[20:23], s31 offen sc1 lds
    s_mov_b32 m0, s38
    s_add_u32 s38, s38, 4224
    buffer_load_dwordx4 v7, s[20:23], s32 offen sc1 lds
    s_add_u32 s31, s31, 4096
    s_add_u32 s32, s32, 4096
    v_lshrrev_b32 v179, 3, v1
    s_lshl_b32 s53, s24, 3
    v_add_u32 v179, s53, v179
    v_mul_u32_u24 v179, 1056, v179
    v_and_b32 v182, 7, v1
    v_lshl_add_u32 v179, v182, 2, v179
    v_add_u32 v179, 66560, v179
    v_cmp_gt_u32 vcc, 4, v182
    v_mov_b32 v183, 0x3f803f80
    s_nop 0
    v_cndmask_b32 v183, 0, v183, vcc
    ds_write_b32 v179, v183
    s_waitcnt vmcnt(0) lgkmcnt(0)
    s_barrier
    v_mov_b32 v176, 0xff800000
    v_mov_b32 v177, 0xff800000
    v_mov_b32 v178, v7
    s_mov_b32 s43, 64
KF_MAXLOOP:
    ds_read_b128 v[88:91], v178
    v_add_u32 v178, 1024, v178
    s_waitcnt lgkmcnt(0)
    v_mfma_f32_32x32x16_bf16 v[16:31], v[88:91], v[8:11], 0
    v_mfma_f32_32x32x16_bf16 v[32:47], v[88:91], v[12:15], 0
    s_nop 10
    v_max3_f32 v176, v176, v16, v17
    v_max3_f32 v176, v176, v18, v19
    v_max3_f32 v176, v176, v20, v21
    v_max3_f32 v176, v176, v22, v23
    v_max3_f32 v176, v176, v24, v25
    v_max3_f32 v176, v176, v26, v27
    v_max3_f32 v176, v176, v28, v29
    v_max3_f32 v176, v176, v30, v31
    v_max3_f32 v177, v177, v32, v33
    v_max3_f32 v177, v177, v34, v35
    v_max3_f32 v177, v177, v36, v37
    v_max3_f32 v177, v177, v38, v39
    v_max3_f32 v177, v177, v40, v41
    v_max3_f32 v177, v177, v42, v43
    v_max3_f32 v177, v177, v44, v45
    v_max3_f32 v177, v177, v46, v47
    s_sub_u32 s43, s43, 1
    s_cmp_lg_u32 s43, 0
    s_cbranch_scc1 KF_MAXLOOP
    v_mov_b32 v178, v176
    v_mov_b32 v179, v177
    s_nop 0
    v_permlane32_swap_b32 v176, v178
    v_permlane32_swap_b32 v177, v179
    v_max_f32 v176, v176, v178
    v_max_f32 v177, v177, v179
    v_subrev_u32 v2, 16384, v2
    v_subrev_u32 v3, 16896, v3
    v_subrev_u32 v4, 16896, v4
    v_sub_f32 v184, 0, v176
    v_sub_f32 v185, 0, v176
    v_sub_f32 v186, 0, v176
    v_sub_f32 v187, 0, v176
    v_sub_f32 v188, 0, v176
    v_sub_f32 v189, 0, v176
    v_sub_f32 v190, 0, v176
    v_sub_f32 v191, 0, v176
    v_sub_f32 v192, 0, v176
    v_sub_f32 v193, 0, v176
    v_sub_f32 v194, 0, v176
    v_sub_f32 v195, 0, v176
    v_sub_f32 v196, 0, v176
    v_sub_f32 v197, 0, v176
    v_sub_f32 v198, 0, v176
    v_sub_f32 v199, 0, v176
    v_sub_f32 v200, 0, v177
    v_sub_f32 v201, 0, v177
    v_sub_f32 v202, 0, v177
    v_sub_f32 v203, 0, v177
    v_sub_f32 v204, 0, v177
    v_sub_f32 v205, 0, v177
    v_sub_f32 v206, 0, v177
    v_sub_f32 v207, 0, v177
    v_sub_f32 v208, 0, v177
    v_sub_f32 v209, 0, v177
    v_sub_f32 v210, 0, v177
    v_sub_f32 v211, 0, v177
    v_sub_f32 v212, 0, v177
    v_sub_f32 v213, 0, v177
    v_sub_f32 v214, 0, v177
    v_sub_f32 v215, 0, v177
    v_mov_b32 v56, 0
    v_mov_b32 v57, 0
    v_mov_b32 v58, 0
    v_mov_b32 v59, 0
    v_mov_b32 v60, 0
    v_mov_b32 v61, 0
    v_mov_b32 v62, 0
    v_mov_b32 v63, 0
    v_mov_b32 v64, 0
    v_mov_b32 v65, 0
    v_mov_b32 v66, 0
    v_mov_b32 v67, 0
    v_mov_b32 v68, 0
    v_mov_b32 v69, 0
    v_mov_b32 v70, 0
    v_mov_b32 v71, 0
    v_mov_b32 v72, 0
    v_mov_b32 v73, 0
    v_mov_b32 v74, 0
    v_mov_b32 v75, 0
    v_mov_b32 v76, 0
    v_mov_b32 v77, 0
    v_mov_b32 v78, 0
    v_mov_b32 v79, 0
    v_mov_b32 v80, 0
    v_mov_b32 v81, 0
    v_mov_b32 v82, 0
    v_mov_b32 v83, 0
    v_mov_b32 v84, 0
    v_mov_b32 v85, 0
    v_mov_b32 v86, 0
    v_mov_b32 v87, 0
    v_mov_b32 v52, 0
    v_mov_b32 v53, 0
    v_mov_b32 v54, 0
    v_mov_b32 v55, 0
    v_mov_b32 v108, 0
    v_mov_b32 v109, 0
    v_mov_b32 v110, 0
    v_mov_b32 v111, 0
    v_mov_b32 v32, 0
    v_mov_b32 v33, 0
    v_mov_b32 v34, 0
    v_mov_b32 v35, 0
    v_mov_b32 v36, 0
    v_mov_b32 v37, 0
    v_mov_b32 v38, 0
    v_mov_b32 v39, 0
    v_mov_b32 v40, 0
    v_mov_b32 v41, 0
    v_mov_b32 v42, 0
    v_mov_b32 v43, 0
    v_mov_b32 v44, 0
    v_mov_b32 v45, 0
    v_mov_b32 v46, 0
    v_mov_b32 v47, 0
    v_mov_b32 v104, 0
    v_mov_b32 v105, 0
    v_mov_b32 v106, 0
    v_mov_b32 v107, 0
    v_mov_b32 v48, 0xdddddddd
    ds_read_b128 v[88:91], v2
    ds_read_b128 v[96:99], v3
    ds_read_b128 v[100:103], v4 offset:512
    s_waitcnt lgkmcnt(2)
    v_mfma_f32_32x32x16_bf16 v[16:31], v[88:91], v[8:11], v[184:199]
    s_mov_b32 s43, 8
    s_waitcnt lgkmcnt(0)
    s_nop 7
    s_nop 3
KF_LF:
    v_exp_f32 v16, v16
    v_exp_f32 v17, v17
    v_smfmac_f32_32x32x32_bf16 v[72:87], v[108:111], v[40:47], v48
    v_exp_f32 v18, v18
    v_exp_f32 v19, v19
    v_exp_f32 v20, v20
    v_mfma_f32_32x32x16_bf16 v[32:47], v[88:91], v[12:15], v[200:215]
    ds_read_b128 v[92:95], v2 offset:1024
    ds_read_b128 v[104:107], v3 offset:1056
    ds_read_b128 v[108:111], v4 offset:1568
    v_exp_f32 v21, v21
    v_exp_f32 v22, v22
    v_exp_f32 v23, v23
    v_exp_f32 v24, v24
    v_exp_f32 v25, v25
    v_exp_f32 v26, v26
    v_smfmac_f32_32x32x32_bf16 v[56:71], v[96:99], v[16:23], v48
    v_exp_f32 v27, v27
    v_exp_f32 v28, v28
    v_exp_f32 v29, v29
    v_exp_f32 v30, v30
    v_exp_f32 v31, v31
    v_exp_f32 v32, v32
    v_exp_f32 v33, v33
    v_smfmac_f32_32x32x32_bf16 v[56:71], v[100:103], v[24:31], v48
    s_waitcnt lgkmcnt(0)
    v_exp_f32 v34, v34
    v_exp_f32 v35, v35
    v_exp_f32 v36, v36
    v_mfma_f32_32x32x16_bf16 v[16:31], v[92:95], v[8:11], v[184:199]
    v_exp_f32 v37, v37
    v_exp_f32 v38, v38
    v_exp_f32 v39, v39
    v_exp_f32 v40, v40
    v_exp_f32 v41, v41
    v_exp_f32 v42, v42
    v_smfmac_f32_32x32x32_bf16 v[72:87], v[96:99], v[32:39], v48
    v_exp_f32 v43, v43
    v_exp_f32 v44, v44
    v_exp_f32 v45, v45
    v_exp_f32 v46, v46
    v_exp_f32 v47, v47
    v_exp_f32 v16, v16
    v_exp_f32 v17, v17
    v_smfmac_f32_32x32x32_bf16 v[72:87], v[100:103], v[40:47], v48
    v_exp_f32 v18, v18
    v_exp_f32 v19, v19
    v_exp_f32 v20, v20
    v_mfma_f32_32x32x16_bf16 v[32:47], v[92:95], v[12:15], v[200:215]
    ds_read_b128 v[88:91], v2 offset:2048
    ds_read_b128 v[96:99], v3 offset:2112
    ds_read_b128 v[100:103], v4 offset:2624
    v_exp_f32 v21, v21
    v_exp_f32 v22, v22
    v_exp_f32 v23, v23
    v_exp_f32 v24, v24
    v_exp_f32 v25, v25
    v_exp_f32 v26, v26
    v_smfmac_f32_32x32x32_bf16 v[56:71], v[104:107], v[16:23], v48
    v_exp_f32 v27, v27
    v_exp_f32 v28, v28
    v_exp_f32 v29, v29
    v_exp_f32 v30, v30
    v_exp_f32 v31, v31
    v_exp_f32 v32, v32
    v_exp_f32 v33, v33
    v_smfmac_f32_32x32x32_bf16 v[56:71], v[108:111], v[24:31], v48
    s_waitcnt lgkmcnt(0)
    v_exp_f32 v34, v34
    v_exp_f32 v35, v35
    v_exp_f32 v36, v36
    v_mfma_f32_32x32x16_bf16 v[16:31], v[88:91], v[8:11], v[184:199]
    v_exp_f32 v37, v37
    v_exp_f32 v38, v38
    v_exp_f32 v39, v39
    v_exp_f32 v40, v40
    v_exp_f32 v41, v41
    v_exp_f32 v42, v42
    v_smfmac_f32_32x32x32_bf16 v[72:87], v[104:107], v[32:39], v48
    v_exp_f32 v43, v43
    v_exp_f32 v44, v44
    v_exp_f32 v45, v45
    v_exp_f32 v46, v46
    v_exp_f32 v47, v47
    v_exp_f32 v16, v16
    v_exp_f32 v17, v17
    v_smfmac_f32_32x32x32_bf16 v[72:87], v[108:111], v[40:47], v48
    v_exp_f32 v18, v18
    v_exp_f32 v19, v19
    v_exp_f32 v20, v20
    v_mfma_f32_32x32x16_bf16 v[32:47], v[88:91], v[12:15], v[200:215]
    ds_read_b128 v[92:95], v2 offset:3072
    ds_read_b128 v[104:107], v3 offset:3168
    ds_read_b128 v[108:111], v4 offset:3680
    v_exp_f32 v21, v21
    v_exp_f32 v22, v22
    v_exp_f32 v23, v23
    v_exp_f32 v24, v24
    v_exp_f32 v25, v25
    v_exp_f32 v26, v26
    v_smfmac_f32_32x32x32_bf16 v[56:71], v[96:99], v[16:23], v48
    v_exp_f32 v27, v27
    v_exp_f32 v28, v28
    v_exp_f32 v29, v29
    v_exp_f32 v30, v30
    v_exp_f32 v31, v31
    v_exp_f32 v32, v32
    v_exp_f32 v33, v33
    v_smfmac_f32_32x32x32_bf16 v[56:71], v[100:103], v[24:31], v48
    s_waitcnt lgkmcnt(0)
    v_exp_f32 v34, v34
    v_exp_f32 v35, v35
    v_exp_f32 v36, v36
    v_mfma_f32_32x32x16_bf16 v[16:31], v[92:95], v[8:11], v[184:199]
    v_exp_f32 v37, v37
    v_exp_f32 v38, v38
    v_exp_f32 v39, v39
    v_exp_f32 v40, v40
    v_exp_f32 v41, v41
    v_exp_f32 v42, v42
    v_smfmac_f32_32x32x32_bf16 v[72:87], v[96:99], v[32:39], v48
    v_exp_f32 v43, v43
    v_exp_f32 v44, v44
    v_exp_f32 v45, v45
    v_exp_f32 v46, v46
    v_exp_f32 v47, v47
    v_exp_f32 v16, v16
    v_exp_f32 v17, v17
    v_smfmac_f32_32x32x32_bf16 v[72:87], v[100:103], v[40:47], v48
    v_exp_f32 v18, v18
    v_exp_f32 v19, v19
    v_exp_f32 v20, v20
    v_mfma_f32_32x32x16_bf16 v[32:47], v[92:95], v[12:15], v[200:215]
    ds_read_b128 v[88:91], v2 offset:4096
    ds_read_b128 v[96:99], v3 offset:4224
    ds_read_b128 v[100:103], v4 offset:4736
    v_exp_f32 v21, v21
    v_exp_f32 v22, v22
    v_exp_f32 v23, v23
    v_exp_f32 v24, v24
    v_exp_f32 v25, v25
    v_exp_f32 v26, v26
    v_smfmac_f32_32x32x32_bf16 v[56:71], v[104:107], v[16:23], v48
    v_exp_f32 v27, v27
    v_exp_f32 v28, v28
    v_exp_f32 v29, v29
    v_exp_f32 v30, v30
    v_exp_f32 v31, v31
    v_exp_f32 v32, v32
    v_exp_f32 v33, v33
    v_smfmac_f32_32x32x32_bf16 v[56:71], v[108:111], v[24:31], v48
    s_waitcnt lgkmcnt(0)
    v_exp_f32 v34, v34
    v_exp_f32 v35, v35
    v_exp_f32 v36, v36
    v_mfma_f32_32x32x16_bf16 v[16:31], v[88:91], v[8:11], v[184:199]
    v_exp_f32 v37, v37
    v_exp_f32 v38, v38
    v_exp_f32 v39, v39
    v_exp_f32 v40, v40
    v_exp_f32 v41, v41
    v_exp_f32 v42, v42
    v_smfmac_f32_32x32x32_bf16 v[72:87], v[104:107], v[32:39], v48
    v_exp_f32 v43, v43
    v_exp_f32 v44, v44
    v_exp_f32 v45, v45
    v_exp_f32 v46, v46
    v_exp_f32 v47, v47
    v_add_u32 v2, 4096, v2
    v_add_u32 v3, 4224, v3
    v_add_u32 v4, 4224, v4
    s_sub_u32 s43, s43, 1
    s_cmp_lg_u32 s43, 0
    s_cbranch_scc1 KF_LF
    s_branch KF_DONE
KF_REWO:
    s_add_u32 s53, s26, 0
    s_and_b32 s53, s53, 7
    s_lshl_b32 s53, s53, 16
    s_add_u32 m0, s47, 0
    s_add_u32 s53, s53, s48
    buffer_load_dwordx4 v5, s[4:7], s53 offen lds
    s_add_u32 s53, s26, 1
    s_and_b32 s53, s53, 7
    s_lshl_b32 s53, s53, 16
    s_add_u32 m0, s47, 8192
    s_add_u32 s53, s53, s48
    buffer_load_dwordx4 v5, s[4:7], s53 offen lds
    s_add_u32 s53, s26, 2
    s_and_b32 s53, s53, 7
    s_lshl_b32 s53, s53, 16
    s_add_u32 m0, s47, 32768
    s_add_u32 s53, s53, s48
    buffer_load_dwordx4 v5, s[4:7], s53 offen lds
    s_add_u32 s53, s26, 3
    s_and_b32 s53, s53, 7
    s_lshl_b32 s53, s53, 16
    s_add_u32 m0, s47, 40960
    s_add_u32 s53, s53, s48
    buffer_load_dwordx4 v5, s[4:7], s53 offen lds
    s_add_u32 s53, s26, 4
    s_and_b32 s53, s53, 7
    s_lshl_b32 s53, s53, 16
    s_add_u32 m0, s47, 65536
    s_add_u32 s53, s53, s48
    buffer_load_dwordx4 v5, s[4:7], s53 offen lds
    s_add_u32 s53, s26, 5
    s_and_b32 s53, s53, 7
    s_lshl_b32 s53, s53, 16
    s_add_u32 m0, s47, 73728
    s_add_u32 s53, s53, s48
    buffer_load_dwordx4 v5, s[4:7], s53 offen lds
    s_add_u32 s53, s26, 6
    s_and_b32 s53, s53, 7
    s_lshl_b32 s53, s53, 16
    s_add_u32 m0, s47, 99328
    s_add_u32 s53, s53, s48
    buffer_load_dwordx4 v5, s[4:7], s53 offen lds
    s_add_u32 s53, s26, 7
    s_and_b32 s53, s53, 7
    s_lshl_b32 s53, s53, 16
    s_add_u32 m0, s47, 107520
    s_add_u32 s53, s53, s48
    buffer_load_dwordx4 v5, s[4:7], s53 offen lds
    s_waitcnt vmcnt(0)
    s_barrier
    s_branch KF_PC3
KF_END:
    s_endpgm
.section .rodata,"a"
.p2align 6
.amdhsa_kernel gated_mix__softmax_full_mha__ssm_conv_s4__prompt_kernel
  .amdhsa_next_free_vgpr 248
  .amdhsa_next_free_sgpr 102
  .amdhsa_accum_offset 248
  .amdhsa_group_segment_fixed_size 0
  .amdhsa_kernarg_size 128
  .amdhsa_user_sgpr_count 2
  .amdhsa_user_sgpr_kernarg_segment_ptr 1
  .amdhsa_system_sgpr_workgroup_id_x 1
.end_amdhsa_kernel
```
